```python
import torch

def _softmax(x, axis=-1):
    return torch.softmax(x, dim=axis)
def _gelu(x):
    return torch.nn.functional.gelu(x, approximate="tanh")
def _silu(x):
    return torch.nn.functional.silu(x)
def _sigmoid(x):
    return torch.sigmoid(x)
def _layernorm(x, axis=-1, eps=1e-5):
    m = x.mean(dim=axis, keepdim=True)
    v = x.var(dim=axis, keepdim=True, unbiased=False)
    return (x - m) / torch.sqrt(v + eps)
def _scatter_add(tgt, idx, src, axis=0):
    return tgt.clone().index_add_(axis, idx, src)
def _segment_sum(src, seg, n):
    out = torch.zeros((n,) + src.shape[1:], dtype=src.dtype)
    return out.index_add_(0, seg, src)
def _pad(x, pw):
    flat = tuple(v for pair in reversed(pw) for v in pair)
    return torch.nn.functional.pad(x, flat)

kernel_name = 'recurrent_scan__gqa_block_cached__swiglu_ffn__decode'

def setup_inputs():

    _w = (lambda a: (lambda t: t.to(torch.bfloat16) if t.is_floating_point() else t)(torch.as_tensor(a)))
    def _A_setup():
        B, Sq, D = 2, 1, 1024
        Hq, Hkv, Sk, Dh = 32, 4, 32768, 128
        assert Hq % Hkv == 0, (Hq, Hkv)
        return {
            "x": _w((lambda *s: torch.randn(*s, dtype=torch.bfloat16) * 0.05)(B, Sq, D)),
            "k_cache": _w((lambda *s: torch.randn(*s, dtype=torch.bfloat16) * 1.6)(B, Hkv, Sk, Dh)),
            "v_cache": _w((lambda *s: torch.randn(*s, dtype=torch.bfloat16) * 0.2)(B, Hkv, Sk, Dh)),
            "wq": _w((lambda *s: torch.randn(*s, dtype=torch.bfloat16) * 1.6)(D, Hq * Dh) * (D ** -0.5)),
            "wo": _w((lambda *s: torch.randn(*s, dtype=torch.bfloat16) * 0.2)(Hq * Dh, D) * ((Hq * Dh) ** -0.5)),
        }
    _A_in = _A_setup()

    def _B_setup():
        B, S, D, F = 2, 1, 1024, 3584
        return {
            "x": _w((lambda *s: torch.randn(*s, dtype=torch.bfloat16) * 0.05)(B, S, D)),
            "w_gate": _w((lambda *s: torch.randn(*s, dtype=torch.bfloat16) * 0.1)(D, F)),
            "w_up": _w((lambda *s: torch.randn(*s, dtype=torch.bfloat16) * 0.1)(D, F)),
            "w_down": _w((lambda *s: torch.randn(*s, dtype=torch.bfloat16) * 0.1)(F, D)),
        }
    _B_in = _B_setup()

    return {
        "A_x": _A_in["x"],
        "A_k_cache": _A_in["k_cache"],
        "A_v_cache": _A_in["v_cache"],
        "A_wq": _A_in["wq"],
        "A_wo": _A_in["wo"],
        "B_x": _B_in["x"],
        "B_w_gate": _B_in["w_gate"],
        "B_w_up": _B_in["w_up"],
        "B_w_down": _B_in["w_down"],
    }

def reference(A_x, A_k_cache, A_v_cache, A_wq, A_wo, B_x, B_w_gate, B_w_up, B_w_down):
    def _A_ref(x, k_cache, v_cache, wq, wo):
        B, Sq, D = x.shape
        Hq, Dh = 32, 128
        Hkv = k_cache.shape[1]
        rep = Hq // Hkv
        q = (lambda x, *d: x.permute(*d))((x @ wq).reshape(B, Sq, Hq, Dh), 0, 2, 1, 3)
        k = (lambda x, n, axis: torch.repeat_interleave(x, n, dim=axis))(k_cache, rep, axis=1)
        v = (lambda x, n, axis: torch.repeat_interleave(x, n, dim=axis))(v_cache, rep, axis=1)
        scores = torch.einsum("bhqd,bhkd->bhqk", q, k) * (Dh ** -0.5)
        p = _softmax(scores, axis=-1)
        o = torch.einsum("bhqk,bhkd->bhqd", p, v)
        return (lambda x, *d: x.permute(*d))(o, 0, 2, 1, 3).reshape(B, Sq, Hq * Dh) @ wo

    def _B_ref(x, w_gate, w_up, w_down):
        g = _silu(x @ w_gate)
        u = x @ w_up
        return (g * u) @ w_down

    x = A_x
    xn = _layernorm(x, axis=-1)
    s = _A_ref(xn, A_k_cache, A_v_cache, A_wq, A_wo)
    g = _silu(_B_ref(xn, B_w_gate, B_w_up, B_w_down))
    return x + s * g
```

```asm
; @launch grid=(256,1,1) block=(512,1,1) lds=163840
.amdgcn_target "amdgcn-amd-amdhsa--gfx950"
.text
.globl recurrent_scan__gqa_block_cached__swiglu_ffn__decode_kernel
.p2align 8
.type recurrent_scan__gqa_block_cached__swiglu_ffn__decode_kernel,@function
recurrent_scan__gqa_block_cached__swiglu_ffn__decode_kernel:
    s_cmp_ge_u32 s2, 256
    s_cbranch_scc1 L_end
    s_load_dwordx16 s[32:47], s[0:1], 0
    s_load_dwordx8 s[48:55], s[0:1], 64
    v_lshrrev_b32 v1, 6, v0
    v_and_b32 v0, 63, v0
    v_readfirstlane_b32 s3, v1
    s_mov_b32 s14, 4194304
    s_waitcnt lgkmcnt(0)
    s_mov_b32 s56, s32
    s_mov_b32 s57, s33
    s_mov_b32 s58, 4096
    s_mov_b32 s59, 0x00020000
    s_mov_b32 s60, s34
    s_mov_b32 s61, s35
    s_mov_b32 s62, 67108864
    s_mov_b32 s63, 0x00020000
    s_mov_b32 s64, s36
    s_mov_b32 s65, s37
    s_mov_b32 s66, 67108864
    s_mov_b32 s67, 0x00020000
    s_mov_b32 s68, s38
    s_mov_b32 s69, s39
    s_mov_b32 s70, 8388608
    s_mov_b32 s71, 0x00020000
    s_mov_b32 s72, s40
    s_mov_b32 s73, s41
    s_mov_b32 s74, 8388608
    s_mov_b32 s75, 0x00020000
    s_cmp_ge_u32 s2, 112
    s_cselect_b32 s76, s46, s44
    s_cselect_b32 s77, s47, s45
    s_cmp_lt_u32 s2, 224
    s_cselect_b32 s78, 0x700000, 0
    s_mov_b32 s79, 0x00020000
    s_mov_b32 s80, s48
    s_mov_b32 s81, s49
    s_mov_b32 s82, 7340032
    s_mov_b32 s83, 0x00020000
    s_cmp_ge_u32 s2, 32
    s_cselect_b32 s82, 0x700000, 0
    s_mov_b32 s84, s50
    s_mov_b32 s85, s51
    s_mov_b32 s86, 4096
    s_mov_b32 s87, 0x00020000
    s_mov_b32 s88, s52
    s_mov_b32 s89, s53
    s_mov_b32 s90, 256
    s_mov_b32 s91, 0x00020000
    s_mov_b32 s92, s54
    s_mov_b32 s93, s55
    s_mov_b32 s94, 5242880
    s_mov_b32 s95, 0x00020000
    s_add_u32 s96, s54, 3145728
    s_addc_u32 s97, s55, 0
    s_mov_b32 s98, 917504
    s_mov_b32 s99, 0x00020000
    s_cmp_ge_u32 s3, 4
    s_cbranch_scc1 L_helper
    v_lshrrev_b32 v1, 4, v0
    v_and_b32 v2, 15, v0
    s_mul_i32 s4, s3, 32768
    s_add_u32 s4, s4, 32768
    v_lshlrev_b32 v3, 1, v1
    v_xor_b32 v3, v3, v2
    v_lshlrev_b32 v7, 4, v3
    v_xor_b32 v8, 0x80, v7
    v_mul_u32_u24 v3, 8192, v1
    v_add_u32 v9, v3, v7
    v_add_u32 v10, v3, v8
    s_and_b32 s5, s2, 7
    s_lshl_b32 s5, s5, 2
    s_add_u32 s5, s5, s3
    s_lshl_b32 s9, s5, 18
    s_lshl_b32 s15, s5, 6
    s_lshr_b32 s6, s2, 3
    s_lshl_b32 s6, s6, 8
    s_add_u32 s9, s9, s6
    s_add_u32 m0, s4, 0
    s_add_u32 s8, s9, 0
    buffer_load_dwordx4 v9, s[68:71], s8 offen offset:0 nt lds
    s_add_u32 s8, s9, 31744
    buffer_load_dwordx4 v10, s[68:71], s8 offen offset:1024 nt lds
    s_add_u32 s8, s9, 63488
    buffer_load_dwordx4 v9, s[68:71], s8 offen offset:2048 nt lds
    s_add_u32 s8, s9, 95232
    buffer_load_dwordx4 v10, s[68:71], s8 offen offset:3072 nt lds
    s_add_u32 m0, s4, 4096
    s_add_u32 s8, s9, 131072
    buffer_load_dwordx4 v9, s[68:71], s8 offen offset:0 nt lds
    s_add_u32 s8, s9, 162816
    buffer_load_dwordx4 v10, s[68:71], s8 offen offset:1024 nt lds
    s_add_u32 s8, s9, 194560
    buffer_load_dwordx4 v9, s[68:71], s8 offen offset:2048 nt lds
    s_add_u32 s8, s9, 226304
    buffer_load_dwordx4 v10, s[68:71], s8 offen offset:3072 nt lds
    v_mul_u32_u24 v3, 7168, v1
    v_add_u32 v11, v3, v7
    v_add_u32 v12, v3, v8
    s_and_b32 s5, s2, 3
    s_lshl_b32 s5, s5, 2
    s_add_u32 s5, s5, s3
    s_mul_i32 s10, s5, 458752
    s_lshl_b32 s7, s5, 7
    s_lshr_b32 s6, s2, 2
    s_cmp_ge_u32 s6, 28
    s_cselect_b32 s5, 28, 0
    s_sub_u32 s6, s6, s5
    s_lshl_b32 s6, s6, 8
    s_add_u32 s10, s10, s6
    s_waitcnt vmcnt(0)
    s_add_u32 m0, s4, 8192
    s_add_u32 s8, s10, 0
    buffer_load_dwordx4 v11, s[76:79], s8 offen offset:0 nt lds
    s_add_u32 s8, s10, 27648
    buffer_load_dwordx4 v12, s[76:79], s8 offen offset:1024 nt lds
    s_add_u32 s8, s10, 55296
    buffer_load_dwordx4 v11, s[76:79], s8 offen offset:2048 nt lds
    s_add_u32 s8, s10, 82944
    buffer_load_dwordx4 v12, s[76:79], s8 offen offset:3072 nt lds
    s_add_u32 m0, s4, 12288
    s_add_u32 s8, s10, 114688
    buffer_load_dwordx4 v11, s[76:79], s8 offen offset:0 nt lds
    s_add_u32 s8, s10, 142336
    buffer_load_dwordx4 v12, s[76:79], s8 offen offset:1024 nt lds
    s_add_u32 s8, s10, 169984
    buffer_load_dwordx4 v11, s[76:79], s8 offen offset:2048 nt lds
    s_add_u32 s8, s10, 197632
    buffer_load_dwordx4 v12, s[76:79], s8 offen offset:3072 nt lds
    s_lshr_b32 s11, s2, 5
    s_lshl_b32 s11, s11, 23
    s_and_b32 s5, s2, 31
    s_lshl_b32 s5, s5, 2
    s_add_u32 s5, s5, s3
    s_lshl_b32 s5, s5, 13
    s_add_u32 s11, s11, s5
    s_lshr_b32 s6, s2, 5
    s_mul_i32 s6, s6, 1
    s_add_u32 s5, s6, 0
    s_and_b32 s5, s5, 7
    s_lshl_b32 s5, s5, 20
    s_add_u32 s50, s11, s5
    s_add_u32 s5, s6, 1
    s_and_b32 s5, s5, 7
    s_lshl_b32 s5, s5, 20
    s_add_u32 s51, s11, s5
    s_add_u32 s5, s6, 2
    s_and_b32 s5, s5, 7
    s_lshl_b32 s5, s5, 20
    s_add_u32 s52, s11, s5
    s_add_u32 s5, s6, 3
    s_and_b32 s5, s5, 7
    s_lshl_b32 s5, s5, 20
    s_add_u32 s53, s11, s5
    s_add_u32 s5, s6, 4
    s_and_b32 s5, s5, 7
    s_lshl_b32 s5, s5, 20
    s_add_u32 s54, s11, s5
    s_add_u32 s5, s6, 5
    s_and_b32 s5, s5, 7
    s_lshl_b32 s5, s5, 20
    s_add_u32 s55, s11, s5
    s_add_u32 s5, s6, 6
    s_and_b32 s5, s5, 7
    s_lshl_b32 s5, s5, 20
    s_add_u32 s32, s11, s5
    s_lshr_b32 s24, s2, 5
    s_lshl_b32 s24, s24, 23
    s_lshr_b32 s5, s2, 3
    s_lshl_b32 s25, s5, 7
    s_add_u32 s25, s25, 1716224
    s_and_b32 s5, s5, 3
    s_mul_i32 s5, s5, 32
    s_lshr_b32 s8, s5, 7
    s_add_u32 s6, s6, s8
    s_add_u32 s6, s6, 7
    s_and_b32 s6, s6, 7
    s_lshl_b32 s6, s6, 20
    s_add_u32 s24, s24, s6
    s_and_b32 s5, s5, 127
    s_lshl_b32 s5, s5, 13
    s_add_u32 s24, s24, s5
    v_xor_b32 v3, v2, v1
    v_lshlrev_b32 v4, 8, v1
    v_xor_b32 v5, 0, v3
    v_lshl_add_u32 v17, v5, 4, v4
    v_xor_b32 v5, 4, v3
    v_lshl_add_u32 v18, v5, 4, v4
    v_xor_b32 v5, 8, v3
    v_lshl_add_u32 v19, v5, 4, v4
    v_xor_b32 v5, 12, v3
    v_lshl_add_u32 v20, v5, 4, v4
    v_mul_u32_u24 v3, 256, v1
    v_add_u32 v15, v3, v7
    v_add_u32 v16, v3, v8
    v_mul_u32_u24 v3, 2048, v1
    v_add_u32 v13, v3, v7
    v_add_u32 v14, v3, v8
    s_max_u32 s5, s2, 32
    s_sub_u32 s5, s5, 32
    s_lshr_b32 s6, s5, 1
    s_lshl_b32 s12, s6, 16
    s_and_b32 s6, s5, 1
    s_lshl_b32 s6, s6, 10
    s_add_u32 s12, s12, s6
    s_lshl_b32 s6, s3, 8
    s_add_u32 s12, s12, s6
    s_lshr_b32 s6, s2, 1
    s_lshl_b32 s13, s6, 16
    s_and_b32 s6, s2, 1
    s_lshl_b32 s6, s6, 10
    s_add_u32 s13, s13, s6
    s_lshl_b32 s6, s3, 8
    s_add_u32 s13, s13, s6
    v_xor_b32 v3, v2, v1
    v_lshlrev_b32 v4, 8, v2
    v_add_u32 v4, s4, v4
    v_xor_b32 v5, 0, v3
    v_lshl_add_u32 v21, v5, 4, v4
    v_xor_b32 v5, 4, v3
    v_lshl_add_u32 v22, v5, 4, v4
    v_xor_b32 v5, 8, v3
    v_lshl_add_u32 v23, v5, 4, v4
    v_xor_b32 v5, 12, v3
    v_lshl_add_u32 v24, v5, 4, v4
    v_lshrrev_b32 v3, 2, v0
    v_lshlrev_b32 v4, 8, v3
    v_add_u32 v4, s4, v4
    v_and_b32 v5, 3, v0
    v_lshl_add_u32 v4, v5, 3, v4
    v_and_b32 v3, 7, v3
    v_xor_b32 v5, 0, v3
    v_lshl_add_u32 v25, v5, 5, v4
    v_xor_b32 v5, 1, v3
    v_lshl_add_u32 v26, v5, 5, v4
    v_xor_b32 v5, 2, v3
    v_lshl_add_u32 v27, v5, 5, v4
    v_xor_b32 v5, 3, v3
    v_lshl_add_u32 v28, v5, 5, v4
    v_xor_b32 v5, 4, v3
    v_lshl_add_u32 v29, v5, 5, v4
    v_xor_b32 v5, 5, v3
    v_lshl_add_u32 v30, v5, 5, v4
    v_xor_b32 v5, 6, v3
    v_lshl_add_u32 v31, v5, 5, v4
    v_xor_b32 v5, 7, v3
    v_lshl_add_u32 v32, v5, 5, v4
    v_and_b32 v3, 1, v2
    v_lshlrev_b32 v4, 3, v1
    v_lshl_add_u32 v33, v3, 11, v4
    v_lshlrev_b32 v4, 4, v1
    v_lshl_add_u32 v34, v2, 9, v4
    v_lshlrev_b32 v4, 4, v2
    v_lshl_add_u32 v35, v1, 12, v4
    s_barrier
    v_add_u32 v6, s15, v33
    ds_read_b64 v[40:41], v6 offset:0
    ds_read_b64 v[42:43], v6 offset:32
    v_add_u32 v6, s7, v33
    ds_read_b64 v[44:45], v6 offset:0
    ds_read_b64 v[46:47], v6 offset:32
    ds_read_b64 v[48:49], v6 offset:64
    ds_read_b64 v[50:51], v6 offset:96
    s_waitcnt lgkmcnt(0)
    ds_read_b64_tr_b16 v[56:57], v25 offset:0
    ds_read_b64_tr_b16 v[58:59], v25 offset:4096
    ds_read_b64_tr_b16 v[60:61], v26 offset:0
    ds_read_b64_tr_b16 v[62:63], v26 offset:4096
    ds_read_b64_tr_b16 v[64:65], v27 offset:0
    ds_read_b64_tr_b16 v[66:67], v27 offset:4096
    ds_read_b64_tr_b16 v[68:69], v28 offset:0
    ds_read_b64_tr_b16 v[70:71], v28 offset:4096
    ds_read_b64_tr_b16 v[72:73], v29 offset:0
    ds_read_b64_tr_b16 v[74:75], v29 offset:4096
    ds_read_b64_tr_b16 v[76:77], v30 offset:0
    ds_read_b64_tr_b16 v[78:79], v30 offset:4096
    ds_read_b64_tr_b16 v[80:81], v31 offset:0
    ds_read_b64_tr_b16 v[82:83], v31 offset:4096
    ds_read_b64_tr_b16 v[84:85], v32 offset:0
    ds_read_b64_tr_b16 v[86:87], v32 offset:4096
    s_waitcnt lgkmcnt(12)
    v_mfma_f32_16x16x32_bf16 v[88:91], v[56:59], v[40:43], 0
    v_mfma_f32_16x16x32_bf16 v[92:95], v[60:63], v[40:43], 0
    s_waitcnt lgkmcnt(8)
    v_mfma_f32_16x16x32_bf16 v[96:99], v[64:67], v[40:43], 0
    v_mfma_f32_16x16x32_bf16 v[100:103], v[68:71], v[40:43], 0
    s_waitcnt lgkmcnt(4)
    v_mfma_f32_16x16x32_bf16 v[104:107], v[72:75], v[40:43], 0
    v_mfma_f32_16x16x32_bf16 v[108:111], v[76:79], v[40:43], 0
    s_waitcnt lgkmcnt(0)
    v_mfma_f32_16x16x32_bf16 v[112:115], v[80:83], v[40:43], 0
    v_mfma_f32_16x16x32_bf16 v[116:119], v[84:87], v[40:43], 0
    s_lshl_b32 s5, s3, 10
    v_add_u32 v6, s5, v34
    s_nop 7
    s_mov_b32 exec_lo, 0x30003
    s_mov_b32 exec_hi, 0x30003
    ds_write_b128 v6, v[88:91] offset:4096
    ds_write_b128 v6, v[92:95] offset:4160
    ds_write_b128 v6, v[96:99] offset:4224
    ds_write_b128 v6, v[100:103] offset:4288
    ds_write_b128 v6, v[104:107] offset:4352
    ds_write_b128 v6, v[108:111] offset:4416
    ds_write_b128 v6, v[112:115] offset:4480
    ds_write_b128 v6, v[116:119] offset:4544
    s_mov_b64 exec, -1
    s_waitcnt lgkmcnt(0)
    s_barrier
    v_mov_b32 v40, v44
    v_mov_b32 v41, v45
    v_mov_b32 v42, v46
    v_mov_b32 v43, v47
    s_nop 1
    s_waitcnt vmcnt(0)
    ds_read_b64_tr_b16 v[56:57], v25 offset:8192
    ds_read_b64_tr_b16 v[58:59], v25 offset:12288
    ds_read_b64_tr_b16 v[60:61], v26 offset:8192
    ds_read_b64_tr_b16 v[62:63], v26 offset:12288
    ds_read_b64_tr_b16 v[64:65], v27 offset:8192
    ds_read_b64_tr_b16 v[66:67], v27 offset:12288
    ds_read_b64_tr_b16 v[68:69], v28 offset:8192
    ds_read_b64_tr_b16 v[70:71], v28 offset:12288
    ds_read_b64_tr_b16 v[72:73], v29 offset:8192
    ds_read_b64_tr_b16 v[74:75], v29 offset:12288
    ds_read_b64_tr_b16 v[76:77], v30 offset:8192
    ds_read_b64_tr_b16 v[78:79], v30 offset:12288
    ds_read_b64_tr_b16 v[80:81], v31 offset:8192
    ds_read_b64_tr_b16 v[82:83], v31 offset:12288
    ds_read_b64_tr_b16 v[84:85], v32 offset:8192
    ds_read_b64_tr_b16 v[86:87], v32 offset:12288
    s_waitcnt lgkmcnt(12)
    v_mfma_f32_16x16x32_bf16 v[88:91], v[56:59], v[40:43], 0
    v_mfma_f32_16x16x32_bf16 v[92:95], v[60:63], v[40:43], 0
    s_waitcnt lgkmcnt(8)
    v_mfma_f32_16x16x32_bf16 v[96:99], v[64:67], v[40:43], 0
    v_mfma_f32_16x16x32_bf16 v[100:103], v[68:71], v[40:43], 0
    s_waitcnt lgkmcnt(4)
    v_mfma_f32_16x16x32_bf16 v[104:107], v[72:75], v[40:43], 0
    v_mfma_f32_16x16x32_bf16 v[108:111], v[76:79], v[40:43], 0
    s_waitcnt lgkmcnt(0)
    v_mfma_f32_16x16x32_bf16 v[112:115], v[80:83], v[40:43], 0
    v_mfma_f32_16x16x32_bf16 v[116:119], v[84:87], v[40:43], 0
    s_add_u32 m0, s4, 16384
    s_add_u32 s8, s10, 229376
    buffer_load_dwordx4 v11, s[76:79], s8 offen offset:0 nt lds
    s_add_u32 s8, s10, 257024
    buffer_load_dwordx4 v12, s[76:79], s8 offen offset:1024 nt lds
    s_add_u32 s8, s10, 284672
    buffer_load_dwordx4 v11, s[76:79], s8 offen offset:2048 nt lds
    s_add_u32 s8, s10, 312320
    buffer_load_dwordx4 v12, s[76:79], s8 offen offset:3072 nt lds
    s_add_u32 m0, s4, 20480
    s_add_u32 s8, s10, 344064
    buffer_load_dwordx4 v11, s[76:79], s8 offen offset:0 nt lds
    s_add_u32 s8, s10, 371712
    buffer_load_dwordx4 v12, s[76:79], s8 offen offset:1024 nt lds
    s_add_u32 s8, s10, 399360
    buffer_load_dwordx4 v11, s[76:79], s8 offen offset:2048 nt lds
    s_add_u32 s8, s10, 427008
    buffer_load_dwordx4 v12, s[76:79], s8 offen offset:3072 nt lds
    s_nop 7
    v_mov_b32 v40, v48
    v_mov_b32 v41, v49
    v_mov_b32 v42, v50
    v_mov_b32 v43, v51
    s_nop 1
    s_waitcnt vmcnt(0)
    ds_read_b64_tr_b16 v[56:57], v25 offset:16384
    ds_read_b64_tr_b16 v[58:59], v25 offset:20480
    ds_read_b64_tr_b16 v[60:61], v26 offset:16384
    ds_read_b64_tr_b16 v[62:63], v26 offset:20480
    ds_read_b64_tr_b16 v[64:65], v27 offset:16384
    ds_read_b64_tr_b16 v[66:67], v27 offset:20480
    ds_read_b64_tr_b16 v[68:69], v28 offset:16384
    ds_read_b64_tr_b16 v[70:71], v28 offset:20480
    ds_read_b64_tr_b16 v[72:73], v29 offset:16384
    ds_read_b64_tr_b16 v[74:75], v29 offset:20480
    ds_read_b64_tr_b16 v[76:77], v30 offset:16384
    ds_read_b64_tr_b16 v[78:79], v30 offset:20480
    ds_read_b64_tr_b16 v[80:81], v31 offset:16384
    ds_read_b64_tr_b16 v[82:83], v31 offset:20480
    ds_read_b64_tr_b16 v[84:85], v32 offset:16384
    ds_read_b64_tr_b16 v[86:87], v32 offset:20480
    s_waitcnt lgkmcnt(12)
    v_mfma_f32_16x16x32_bf16 v[88:91], v[56:59], v[40:43], v[88:91]
    v_mfma_f32_16x16x32_bf16 v[92:95], v[60:63], v[40:43], v[92:95]
    s_waitcnt lgkmcnt(8)
    v_mfma_f32_16x16x32_bf16 v[96:99], v[64:67], v[40:43], v[96:99]
    v_mfma_f32_16x16x32_bf16 v[100:103], v[68:71], v[40:43], v[100:103]
    s_waitcnt lgkmcnt(4)
    v_mfma_f32_16x16x32_bf16 v[104:107], v[72:75], v[40:43], v[104:107]
    v_mfma_f32_16x16x32_bf16 v[108:111], v[76:79], v[40:43], v[108:111]
    s_waitcnt lgkmcnt(0)
    v_mfma_f32_16x16x32_bf16 v[112:115], v[80:83], v[40:43], v[112:115]
    v_mfma_f32_16x16x32_bf16 v[116:119], v[84:87], v[40:43], v[116:119]
    s_nop 7
    s_mov_b32 exec_lo, 0x30003
    s_mov_b32 exec_hi, 0x30003
    ds_write_b128 v6, v[88:91] offset:8192
    ds_write_b128 v6, v[92:95] offset:8256
    ds_write_b128 v6, v[96:99] offset:8320
    ds_write_b128 v6, v[100:103] offset:8384
    ds_write_b128 v6, v[104:107] offset:8448
    ds_write_b128 v6, v[108:111] offset:8512
    ds_write_b128 v6, v[112:115] offset:8576
    ds_write_b128 v6, v[116:119] offset:8640
    s_mov_b64 exec, -1
    s_waitcnt lgkmcnt(0)
    s_barrier
    s_add_u32 m0, s4, 24576
    s_add_u32 s8, s50, 0
    buffer_load_dwordx4 v17, s[60:63], s8 offen offset:0 nt lds
    buffer_load_dwordx4 v18, s[60:63], s8 offen offset:1024 nt lds
    buffer_load_dwordx4 v19, s[60:63], s8 offen offset:2048 nt lds
    buffer_load_dwordx4 v20, s[60:63], s8 offen offset:3072 nt lds
    s_add_u32 m0, s4, 28672
    s_add_u32 s8, s50, 4096
    buffer_load_dwordx4 v17, s[60:63], s8 offen offset:0 nt lds
    buffer_load_dwordx4 v18, s[60:63], s8 offen offset:1024 nt lds
    buffer_load_dwordx4 v19, s[60:63], s8 offen offset:2048 nt lds
    buffer_load_dwordx4 v20, s[60:63], s8 offen offset:3072 nt lds
    s_waitcnt vmcnt(0)
    s_add_u32 m0, s4, 0
    s_add_u32 s8, s51, 0
    buffer_load_dwordx4 v17, s[60:63], s8 offen offset:0 nt lds
    buffer_load_dwordx4 v18, s[60:63], s8 offen offset:1024 nt lds
    buffer_load_dwordx4 v19, s[60:63], s8 offen offset:2048 nt lds
    buffer_load_dwordx4 v20, s[60:63], s8 offen offset:3072 nt lds
    s_add_u32 m0, s4, 4096
    s_add_u32 s8, s51, 4096
    buffer_load_dwordx4 v17, s[60:63], s8 offen offset:0 nt lds
    buffer_load_dwordx4 v18, s[60:63], s8 offen offset:1024 nt lds
    buffer_load_dwordx4 v19, s[60:63], s8 offen offset:2048 nt lds
    buffer_load_dwordx4 v20, s[60:63], s8 offen offset:3072 nt lds
    s_waitcnt vmcnt(0)
    s_add_u32 m0, s4, 8192
    s_add_u32 s8, s52, 0
    buffer_load_dwordx4 v17, s[60:63], s8 offen offset:0 nt lds
    buffer_load_dwordx4 v18, s[60:63], s8 offen offset:1024 nt lds
    buffer_load_dwordx4 v19, s[60:63], s8 offen offset:2048 nt lds
    buffer_load_dwordx4 v20, s[60:63], s8 offen offset:3072 nt lds
    s_add_u32 m0, s4, 12288
    s_add_u32 s8, s52, 4096
    buffer_load_dwordx4 v17, s[60:63], s8 offen offset:0 nt lds
    buffer_load_dwordx4 v18, s[60:63], s8 offen offset:1024 nt lds
    buffer_load_dwordx4 v19, s[60:63], s8 offen offset:2048 nt lds
    buffer_load_dwordx4 v20, s[60:63], s8 offen offset:3072 nt lds
    s_waitcnt vmcnt(0)
    s_add_u32 m0, s4, 16384
    s_add_u32 s8, s53, 0
    buffer_load_dwordx4 v17, s[60:63], s8 offen offset:0 nt lds
    buffer_load_dwordx4 v18, s[60:63], s8 offen offset:1024 nt lds
    buffer_load_dwordx4 v19, s[60:63], s8 offen offset:2048 nt lds
    buffer_load_dwordx4 v20, s[60:63], s8 offen offset:3072 nt lds
    s_add_u32 m0, s4, 20480
    s_add_u32 s8, s53, 4096
    buffer_load_dwordx4 v17, s[60:63], s8 offen offset:0 nt lds
    buffer_load_dwordx4 v18, s[60:63], s8 offen offset:1024 nt lds
    buffer_load_dwordx4 v19, s[60:63], s8 offen offset:2048 nt lds
    buffer_load_dwordx4 v20, s[60:63], s8 offen offset:3072 nt lds
    ds_read_b128 v[88:91], v21 offset:24576
    ds_read_b128 v[92:95], v22 offset:24576
    ds_read_b128 v[96:99], v23 offset:24576
    ds_read_b128 v[100:103], v24 offset:24576
    ds_read_b128 v[104:107], v21 offset:28672
    ds_read_b128 v[108:111], v22 offset:28672
    ds_read_b128 v[112:115], v23 offset:28672
    ds_read_b128 v[116:119], v24 offset:28672
    s_waitcnt lgkmcnt(0)
    s_waitcnt vmcnt(0)
    s_add_u32 m0, s4, 24576
    s_add_u32 s8, s54, 0
    buffer_load_dwordx4 v17, s[60:63], s8 offen offset:0 nt lds
    buffer_load_dwordx4 v18, s[60:63], s8 offen offset:1024 nt lds
    buffer_load_dwordx4 v19, s[60:63], s8 offen offset:2048 nt lds
    buffer_load_dwordx4 v20, s[60:63], s8 offen offset:3072 nt lds
    s_add_u32 m0, s4, 28672
    s_add_u32 s8, s54, 4096
    buffer_load_dwordx4 v17, s[60:63], s8 offen offset:0 nt lds
    buffer_load_dwordx4 v18, s[60:63], s8 offen offset:1024 nt lds
    buffer_load_dwordx4 v19, s[60:63], s8 offen offset:2048 nt lds
    buffer_load_dwordx4 v20, s[60:63], s8 offen offset:3072 nt lds
    ds_read_b128 v[176:179], v21 offset:0
    ds_read_b128 v[180:183], v22 offset:0
    ds_read_b128 v[184:187], v23 offset:0
    ds_read_b128 v[188:191], v24 offset:0
    ds_read_b128 v[192:195], v21 offset:4096
    ds_read_b128 v[196:199], v22 offset:4096
    ds_read_b128 v[200:203], v23 offset:4096
    ds_read_b128 v[204:207], v24 offset:4096
    s_waitcnt lgkmcnt(0)
    s_waitcnt vmcnt(0)
    s_add_u32 m0, s4, 0
    s_add_u32 s8, s55, 0
    buffer_load_dwordx4 v17, s[60:63], s8 offen offset:0 nt lds
    buffer_load_dwordx4 v18, s[60:63], s8 offen offset:1024 nt lds
    buffer_load_dwordx4 v19, s[60:63], s8 offen offset:2048 nt lds
    buffer_load_dwordx4 v20, s[60:63], s8 offen offset:3072 nt lds
    s_add_u32 m0, s4, 4096
    s_add_u32 s8, s55, 4096
    buffer_load_dwordx4 v17, s[60:63], s8 offen offset:0 nt lds
    buffer_load_dwordx4 v18, s[60:63], s8 offen offset:1024 nt lds
    buffer_load_dwordx4 v19, s[60:63], s8 offen offset:2048 nt lds
    buffer_load_dwordx4 v20, s[60:63], s8 offen offset:3072 nt lds
    ds_read_b128 v[208:211], v21 offset:8192
    ds_read_b128 v[212:215], v22 offset:8192
    ds_read_b128 v[216:219], v23 offset:8192
    ds_read_b128 v[220:223], v24 offset:8192
    ds_read_b128 v[224:227], v21 offset:12288
    ds_read_b128 v[228:231], v22 offset:12288
    ds_read_b128 v[232:235], v23 offset:12288
    ds_read_b128 v[236:239], v24 offset:12288
    s_waitcnt lgkmcnt(0)
    s_waitcnt vmcnt(0)
    s_add_u32 m0, s4, 8192
    s_add_u32 s8, s32, 0
    buffer_load_dwordx4 v17, s[60:63], s8 offen offset:0 nt lds
    buffer_load_dwordx4 v18, s[60:63], s8 offen offset:1024 nt lds
    buffer_load_dwordx4 v19, s[60:63], s8 offen offset:2048 nt lds
    buffer_load_dwordx4 v20, s[60:63], s8 offen offset:3072 nt lds
    s_add_u32 m0, s4, 12288
    s_add_u32 s8, s32, 4096
    buffer_load_dwordx4 v17, s[60:63], s8 offen offset:0 nt lds
    buffer_load_dwordx4 v18, s[60:63], s8 offen offset:1024 nt lds
    buffer_load_dwordx4 v19, s[60:63], s8 offen offset:2048 nt lds
    buffer_load_dwordx4 v20, s[60:63], s8 offen offset:3072 nt lds
    ds_read_b128 v[56:59], v21 offset:16384
    ds_read_b128 v[60:63], v22 offset:16384
    ds_read_b128 v[64:67], v23 offset:16384
    ds_read_b128 v[68:71], v24 offset:16384
    ds_read_b128 v[72:75], v21 offset:20480
    ds_read_b128 v[76:79], v22 offset:20480
    ds_read_b128 v[80:83], v23 offset:20480
    ds_read_b128 v[84:87], v24 offset:20480
    s_waitcnt lgkmcnt(0)
    s_waitcnt vmcnt(0)
    s_add_u32 m0, s4, 16384
    s_add_u32 s8, s50, 0
    buffer_load_dwordx4 v15, s[64:67], s8 offen offset:0 nt lds
    buffer_load_dwordx4 v16, s[64:67], s8 offen offset:1024 nt lds
    buffer_load_dwordx4 v15, s[64:67], s8 offen offset:2048 nt lds
    buffer_load_dwordx4 v16, s[64:67], s8 offen offset:3072 nt lds
    s_add_u32 m0, s4, 20480
    s_add_u32 s8, s50, 4096
    buffer_load_dwordx4 v15, s[64:67], s8 offen offset:0 nt lds
    buffer_load_dwordx4 v16, s[64:67], s8 offen offset:1024 nt lds
    buffer_load_dwordx4 v15, s[64:67], s8 offen offset:2048 nt lds
    buffer_load_dwordx4 v16, s[64:67], s8 offen offset:3072 nt lds
    s_barrier
    v_and_b32 v3, 7, v2
    v_lshlrev_b32 v4, 4, v1
    v_lshl_add_u32 v3, v3, 8, v4
    ds_read_b128 v[40:43], v3 offset:12288
    ds_read_b128 v[44:47], v3 offset:12352
    ds_read_b128 v[48:51], v3 offset:12416
    ds_read_b128 v[52:55], v3 offset:12480
    s_mov_b32 s5, 0x3db504f3
    s_mov_b32 s6, 0xffff0000
    v_mov_b32 v36, 0xff800000
    s_waitcnt lgkmcnt(0)
    v_mfma_f32_16x16x32_bf16 v[120:123], v[88:91], v[40:43], 0
    v_mfma_f32_16x16x32_bf16 v[120:123], v[92:95], v[44:47], v[120:123]
    v_mfma_f32_16x16x32_bf16 v[120:123], v[96:99], v[48:51], v[120:123]
    v_mfma_f32_16x16x32_bf16 v[120:123], v[100:103], v[52:55], v[120:123]
    v_mfma_f32_16x16x32_bf16 v[124:127], v[104:107], v[40:43], 0
    v_mfma_f32_16x16x32_bf16 v[124:127], v[108:111], v[44:47], v[124:127]
    v_mfma_f32_16x16x32_bf16 v[124:127], v[112:115], v[48:51], v[124:127]
    v_mfma_f32_16x16x32_bf16 v[124:127], v[116:119], v[52:55], v[124:127]
    s_nop 7
    v_cvt_pk_bf16_f32 v5, v120, v121
    v_lshlrev_b32 v120, 16, v5
    v_and_b32 v121, s6, v5
    v_mul_f32 v120, s5, v120
    v_mul_f32 v121, s5, v121
    v_cvt_pk_bf16_f32 v5, v120, v121
    v_lshlrev_b32 v120, 16, v5
    v_and_b32 v121, s6, v5
    v_max3_f32 v36, v120, v121, v36
    v_cvt_pk_bf16_f32 v5, v122, v123
    v_lshlrev_b32 v122, 16, v5
    v_and_b32 v123, s6, v5
    v_mul_f32 v122, s5, v122
    v_mul_f32 v123, s5, v123
    v_cvt_pk_bf16_f32 v5, v122, v123
    v_lshlrev_b32 v122, 16, v5
    v_and_b32 v123, s6, v5
    v_max3_f32 v36, v122, v123, v36
    v_cvt_pk_bf16_f32 v5, v124, v125
    v_lshlrev_b32 v124, 16, v5
    v_and_b32 v125, s6, v5
    v_mul_f32 v124, s5, v124
    v_mul_f32 v125, s5, v125
    v_cvt_pk_bf16_f32 v5, v124, v125
    v_lshlrev_b32 v124, 16, v5
    v_and_b32 v125, s6, v5
    v_max3_f32 v36, v124, v125, v36
    v_cvt_pk_bf16_f32 v5, v126, v127
    v_lshlrev_b32 v126, 16, v5
    v_and_b32 v127, s6, v5
    v_mul_f32 v126, s5, v126
    v_mul_f32 v127, s5, v127
    v_cvt_pk_bf16_f32 v5, v126, v127
    v_lshlrev_b32 v126, 16, v5
    v_and_b32 v127, s6, v5
    v_max3_f32 v36, v126, v127, v36
    v_mfma_f32_16x16x32_bf16 v[128:131], v[176:179], v[40:43], 0
    v_mfma_f32_16x16x32_bf16 v[128:131], v[180:183], v[44:47], v[128:131]
    v_mfma_f32_16x16x32_bf16 v[128:131], v[184:187], v[48:51], v[128:131]
    v_mfma_f32_16x16x32_bf16 v[128:131], v[188:191], v[52:55], v[128:131]
    v_mfma_f32_16x16x32_bf16 v[132:135], v[192:195], v[40:43], 0
    v_mfma_f32_16x16x32_bf16 v[132:135], v[196:199], v[44:47], v[132:135]
    v_mfma_f32_16x16x32_bf16 v[132:135], v[200:203], v[48:51], v[132:135]
    v_mfma_f32_16x16x32_bf16 v[132:135], v[204:207], v[52:55], v[132:135]
    s_nop 7
    v_cvt_pk_bf16_f32 v5, v128, v129
    v_lshlrev_b32 v128, 16, v5
    v_and_b32 v129, s6, v5
    v_mul_f32 v128, s5, v128
    v_mul_f32 v129, s5, v129
    v_cvt_pk_bf16_f32 v5, v128, v129
    v_lshlrev_b32 v128, 16, v5
    v_and_b32 v129, s6, v5
    v_max3_f32 v36, v128, v129, v36
    v_cvt_pk_bf16_f32 v5, v130, v131
    v_lshlrev_b32 v130, 16, v5
    v_and_b32 v131, s6, v5
    v_mul_f32 v130, s5, v130
    v_mul_f32 v131, s5, v131
    v_cvt_pk_bf16_f32 v5, v130, v131
    v_lshlrev_b32 v130, 16, v5
    v_and_b32 v131, s6, v5
    v_max3_f32 v36, v130, v131, v36
    v_cvt_pk_bf16_f32 v5, v132, v133
    v_lshlrev_b32 v132, 16, v5
    v_and_b32 v133, s6, v5
    v_mul_f32 v132, s5, v132
    v_mul_f32 v133, s5, v133
    v_cvt_pk_bf16_f32 v5, v132, v133
    v_lshlrev_b32 v132, 16, v5
    v_and_b32 v133, s6, v5
    v_max3_f32 v36, v132, v133, v36
    v_cvt_pk_bf16_f32 v5, v134, v135
    v_lshlrev_b32 v134, 16, v5
    v_and_b32 v135, s6, v5
    v_mul_f32 v134, s5, v134
    v_mul_f32 v135, s5, v135
    v_cvt_pk_bf16_f32 v5, v134, v135
    v_lshlrev_b32 v134, 16, v5
    v_and_b32 v135, s6, v5
    v_max3_f32 v36, v134, v135, v36
    v_mfma_f32_16x16x32_bf16 v[136:139], v[208:211], v[40:43], 0
    v_mfma_f32_16x16x32_bf16 v[136:139], v[212:215], v[44:47], v[136:139]
    v_mfma_f32_16x16x32_bf16 v[136:139], v[216:219], v[48:51], v[136:139]
    v_mfma_f32_16x16x32_bf16 v[136:139], v[220:223], v[52:55], v[136:139]
    v_mfma_f32_16x16x32_bf16 v[140:143], v[224:227], v[40:43], 0
    v_mfma_f32_16x16x32_bf16 v[140:143], v[228:231], v[44:47], v[140:143]
    v_mfma_f32_16x16x32_bf16 v[140:143], v[232:235], v[48:51], v[140:143]
    v_mfma_f32_16x16x32_bf16 v[140:143], v[236:239], v[52:55], v[140:143]
    s_nop 7
    v_cvt_pk_bf16_f32 v5, v136, v137
    v_lshlrev_b32 v136, 16, v5
    v_and_b32 v137, s6, v5
    v_mul_f32 v136, s5, v136
    v_mul_f32 v137, s5, v137
    v_cvt_pk_bf16_f32 v5, v136, v137
    v_lshlrev_b32 v136, 16, v5
    v_and_b32 v137, s6, v5
    v_max3_f32 v36, v136, v137, v36
    v_cvt_pk_bf16_f32 v5, v138, v139
    v_lshlrev_b32 v138, 16, v5
    v_and_b32 v139, s6, v5
    v_mul_f32 v138, s5, v138
    v_mul_f32 v139, s5, v139
    v_cvt_pk_bf16_f32 v5, v138, v139
    v_lshlrev_b32 v138, 16, v5
    v_and_b32 v139, s6, v5
    v_max3_f32 v36, v138, v139, v36
    v_cvt_pk_bf16_f32 v5, v140, v141
    v_lshlrev_b32 v140, 16, v5
    v_and_b32 v141, s6, v5
    v_mul_f32 v140, s5, v140
    v_mul_f32 v141, s5, v141
    v_cvt_pk_bf16_f32 v5, v140, v141
    v_lshlrev_b32 v140, 16, v5
    v_and_b32 v141, s6, v5
    v_max3_f32 v36, v140, v141, v36
    v_cvt_pk_bf16_f32 v5, v142, v143
    v_lshlrev_b32 v142, 16, v5
    v_and_b32 v143, s6, v5
    v_mul_f32 v142, s5, v142
    v_mul_f32 v143, s5, v143
    v_cvt_pk_bf16_f32 v5, v142, v143
    v_lshlrev_b32 v142, 16, v5
    v_and_b32 v143, s6, v5
    v_max3_f32 v36, v142, v143, v36
    v_mfma_f32_16x16x32_bf16 v[144:147], v[56:59], v[40:43], 0
    v_mfma_f32_16x16x32_bf16 v[144:147], v[60:63], v[44:47], v[144:147]
    v_mfma_f32_16x16x32_bf16 v[144:147], v[64:67], v[48:51], v[144:147]
    v_mfma_f32_16x16x32_bf16 v[144:147], v[68:71], v[52:55], v[144:147]
    v_mfma_f32_16x16x32_bf16 v[148:151], v[72:75], v[40:43], 0
    v_mfma_f32_16x16x32_bf16 v[148:151], v[76:79], v[44:47], v[148:151]
    v_mfma_f32_16x16x32_bf16 v[148:151], v[80:83], v[48:51], v[148:151]
    v_mfma_f32_16x16x32_bf16 v[148:151], v[84:87], v[52:55], v[148:151]
    s_nop 7
    v_cvt_pk_bf16_f32 v5, v144, v145
    v_lshlrev_b32 v144, 16, v5
    v_and_b32 v145, s6, v5
    v_mul_f32 v144, s5, v144
    v_mul_f32 v145, s5, v145
    v_cvt_pk_bf16_f32 v5, v144, v145
    v_lshlrev_b32 v144, 16, v5
    v_and_b32 v145, s6, v5
    v_max3_f32 v36, v144, v145, v36
    v_cvt_pk_bf16_f32 v5, v146, v147
    v_lshlrev_b32 v146, 16, v5
    v_and_b32 v147, s6, v5
    v_mul_f32 v146, s5, v146
    v_mul_f32 v147, s5, v147
    v_cvt_pk_bf16_f32 v5, v146, v147
    v_lshlrev_b32 v146, 16, v5
    v_and_b32 v147, s6, v5
    v_max3_f32 v36, v146, v147, v36
    v_cvt_pk_bf16_f32 v5, v148, v149
    v_lshlrev_b32 v148, 16, v5
    v_and_b32 v149, s6, v5
    v_mul_f32 v148, s5, v148
    v_mul_f32 v149, s5, v149
    v_cvt_pk_bf16_f32 v5, v148, v149
    v_lshlrev_b32 v148, 16, v5
    v_and_b32 v149, s6, v5
    v_max3_f32 v36, v148, v149, v36
    v_cvt_pk_bf16_f32 v5, v150, v151
    v_lshlrev_b32 v150, 16, v5
    v_and_b32 v151, s6, v5
    v_mul_f32 v150, s5, v150
    v_mul_f32 v151, s5, v151
    v_cvt_pk_bf16_f32 v5, v150, v151
    v_lshlrev_b32 v150, 16, v5
    v_and_b32 v151, s6, v5
    v_max3_f32 v36, v150, v151, v36
    ds_read_b128 v[56:59], v21 offset:24576
    ds_read_b128 v[60:63], v22 offset:24576
    ds_read_b128 v[64:67], v23 offset:24576
    ds_read_b128 v[68:71], v24 offset:24576
    ds_read_b128 v[72:75], v21 offset:28672
    ds_read_b128 v[76:79], v22 offset:28672
    ds_read_b128 v[80:83], v23 offset:28672
    ds_read_b128 v[84:87], v24 offset:28672
    s_waitcnt lgkmcnt(4)
    v_mfma_f32_16x16x32_bf16 v[152:155], v[56:59], v[40:43], 0
    v_mfma_f32_16x16x32_bf16 v[152:155], v[60:63], v[44:47], v[152:155]
    v_mfma_f32_16x16x32_bf16 v[152:155], v[64:67], v[48:51], v[152:155]
    v_mfma_f32_16x16x32_bf16 v[152:155], v[68:71], v[52:55], v[152:155]
    s_waitcnt lgkmcnt(0)
    v_mfma_f32_16x16x32_bf16 v[156:159], v[72:75], v[40:43], 0
    v_mfma_f32_16x16x32_bf16 v[156:159], v[76:79], v[44:47], v[156:159]
    v_mfma_f32_16x16x32_bf16 v[156:159], v[80:83], v[48:51], v[156:159]
    v_mfma_f32_16x16x32_bf16 v[156:159], v[84:87], v[52:55], v[156:159]
    s_waitcnt vmcnt(0)
    s_add_u32 m0, s4, 24576
    s_add_u32 s8, s51, 0
    buffer_load_dwordx4 v15, s[64:67], s8 offen offset:0 nt lds
    buffer_load_dwordx4 v16, s[64:67], s8 offen offset:1024 nt lds
    buffer_load_dwordx4 v15, s[64:67], s8 offen offset:2048 nt lds
    buffer_load_dwordx4 v16, s[64:67], s8 offen offset:3072 nt lds
    s_add_u32 m0, s4, 28672
    s_add_u32 s8, s51, 4096
    buffer_load_dwordx4 v15, s[64:67], s8 offen offset:0 nt lds
    buffer_load_dwordx4 v16, s[64:67], s8 offen offset:1024 nt lds
    buffer_load_dwordx4 v15, s[64:67], s8 offen offset:2048 nt lds
    buffer_load_dwordx4 v16, s[64:67], s8 offen offset:3072 nt lds
    s_nop 7
    v_cvt_pk_bf16_f32 v5, v152, v153
    v_lshlrev_b32 v152, 16, v5
    v_and_b32 v153, s6, v5
    v_mul_f32 v152, s5, v152
    v_mul_f32 v153, s5, v153
    v_cvt_pk_bf16_f32 v5, v152, v153
    v_lshlrev_b32 v152, 16, v5
    v_and_b32 v153, s6, v5
    v_max3_f32 v36, v152, v153, v36
    v_cvt_pk_bf16_f32 v5, v154, v155
    v_lshlrev_b32 v154, 16, v5
    v_and_b32 v155, s6, v5
    v_mul_f32 v154, s5, v154
    v_mul_f32 v155, s5, v155
    v_cvt_pk_bf16_f32 v5, v154, v155
    v_lshlrev_b32 v154, 16, v5
    v_and_b32 v155, s6, v5
    v_max3_f32 v36, v154, v155, v36
    v_cvt_pk_bf16_f32 v5, v156, v157
    v_lshlrev_b32 v156, 16, v5
    v_and_b32 v157, s6, v5
    v_mul_f32 v156, s5, v156
    v_mul_f32 v157, s5, v157
    v_cvt_pk_bf16_f32 v5, v156, v157
    v_lshlrev_b32 v156, 16, v5
    v_and_b32 v157, s6, v5
    v_max3_f32 v36, v156, v157, v36
    v_cvt_pk_bf16_f32 v5, v158, v159
    v_lshlrev_b32 v158, 16, v5
    v_and_b32 v159, s6, v5
    v_mul_f32 v158, s5, v158
    v_mul_f32 v159, s5, v159
    v_cvt_pk_bf16_f32 v5, v158, v159
    v_lshlrev_b32 v158, 16, v5
    v_and_b32 v159, s6, v5
    v_max3_f32 v36, v158, v159, v36
    ds_read_b128 v[56:59], v21 offset:0
    ds_read_b128 v[60:63], v22 offset:0
    ds_read_b128 v[64:67], v23 offset:0
    ds_read_b128 v[68:71], v24 offset:0
    ds_read_b128 v[72:75], v21 offset:4096
    ds_read_b128 v[76:79], v22 offset:4096
    ds_read_b128 v[80:83], v23 offset:4096
    ds_read_b128 v[84:87], v24 offset:4096
    s_waitcnt lgkmcnt(4)
    v_mfma_f32_16x16x32_bf16 v[160:163], v[56:59], v[40:43], 0
    v_mfma_f32_16x16x32_bf16 v[160:163], v[60:63], v[44:47], v[160:163]
    v_mfma_f32_16x16x32_bf16 v[160:163], v[64:67], v[48:51], v[160:163]
    v_mfma_f32_16x16x32_bf16 v[160:163], v[68:71], v[52:55], v[160:163]
    s_waitcnt lgkmcnt(0)
    v_mfma_f32_16x16x32_bf16 v[164:167], v[72:75], v[40:43], 0
    v_mfma_f32_16x16x32_bf16 v[164:167], v[76:79], v[44:47], v[164:167]
    v_mfma_f32_16x16x32_bf16 v[164:167], v[80:83], v[48:51], v[164:167]
    v_mfma_f32_16x16x32_bf16 v[164:167], v[84:87], v[52:55], v[164:167]
    s_waitcnt vmcnt(0)
    s_add_u32 m0, s4, 0
    s_add_u32 s8, s52, 0
    buffer_load_dwordx4 v15, s[64:67], s8 offen offset:0 nt lds
    buffer_load_dwordx4 v16, s[64:67], s8 offen offset:1024 nt lds
    buffer_load_dwordx4 v15, s[64:67], s8 offen offset:2048 nt lds
    buffer_load_dwordx4 v16, s[64:67], s8 offen offset:3072 nt lds
    s_add_u32 m0, s4, 4096
    s_add_u32 s8, s52, 4096
    buffer_load_dwordx4 v15, s[64:67], s8 offen offset:0 nt lds
    buffer_load_dwordx4 v16, s[64:67], s8 offen offset:1024 nt lds
    buffer_load_dwordx4 v15, s[64:67], s8 offen offset:2048 nt lds
    buffer_load_dwordx4 v16, s[64:67], s8 offen offset:3072 nt lds
    s_nop 7
    v_cvt_pk_bf16_f32 v5, v160, v161
    v_lshlrev_b32 v160, 16, v5
    v_and_b32 v161, s6, v5
    v_mul_f32 v160, s5, v160
    v_mul_f32 v161, s5, v161
    v_cvt_pk_bf16_f32 v5, v160, v161
    v_lshlrev_b32 v160, 16, v5
    v_and_b32 v161, s6, v5
    v_max3_f32 v36, v160, v161, v36
    v_cvt_pk_bf16_f32 v5, v162, v163
    v_lshlrev_b32 v162, 16, v5
    v_and_b32 v163, s6, v5
    v_mul_f32 v162, s5, v162
    v_mul_f32 v163, s5, v163
    v_cvt_pk_bf16_f32 v5, v162, v163
    v_lshlrev_b32 v162, 16, v5
    v_and_b32 v163, s6, v5
    v_max3_f32 v36, v162, v163, v36
    v_cvt_pk_bf16_f32 v5, v164, v165
    v_lshlrev_b32 v164, 16, v5
    v_and_b32 v165, s6, v5
    v_mul_f32 v164, s5, v164
    v_mul_f32 v165, s5, v165
    v_cvt_pk_bf16_f32 v5, v164, v165
    v_lshlrev_b32 v164, 16, v5
    v_and_b32 v165, s6, v5
    v_max3_f32 v36, v164, v165, v36
    v_cvt_pk_bf16_f32 v5, v166, v167
    v_lshlrev_b32 v166, 16, v5
    v_and_b32 v167, s6, v5
    v_mul_f32 v166, s5, v166
    v_mul_f32 v167, s5, v167
    v_cvt_pk_bf16_f32 v5, v166, v167
    v_lshlrev_b32 v166, 16, v5
    v_and_b32 v167, s6, v5
    v_max3_f32 v36, v166, v167, v36
    ds_read_b128 v[56:59], v21 offset:8192
    ds_read_b128 v[60:63], v22 offset:8192
    ds_read_b128 v[64:67], v23 offset:8192
    ds_read_b128 v[68:71], v24 offset:8192
    ds_read_b128 v[72:75], v21 offset:12288
    ds_read_b128 v[76:79], v22 offset:12288
    ds_read_b128 v[80:83], v23 offset:12288
    ds_read_b128 v[84:87], v24 offset:12288
    s_waitcnt lgkmcnt(4)
    v_mfma_f32_16x16x32_bf16 v[168:171], v[56:59], v[40:43], 0
    v_mfma_f32_16x16x32_bf16 v[168:171], v[60:63], v[44:47], v[168:171]
    v_mfma_f32_16x16x32_bf16 v[168:171], v[64:67], v[48:51], v[168:171]
    v_mfma_f32_16x16x32_bf16 v[168:171], v[68:71], v[52:55], v[168:171]
    s_waitcnt lgkmcnt(0)
    v_mfma_f32_16x16x32_bf16 v[172:175], v[72:75], v[40:43], 0
    v_mfma_f32_16x16x32_bf16 v[172:175], v[76:79], v[44:47], v[172:175]
    v_mfma_f32_16x16x32_bf16 v[172:175], v[80:83], v[48:51], v[172:175]
    v_mfma_f32_16x16x32_bf16 v[172:175], v[84:87], v[52:55], v[172:175]
    s_waitcnt vmcnt(0)
    s_add_u32 m0, s4, 8192
    s_add_u32 s8, s53, 0
    buffer_load_dwordx4 v15, s[64:67], s8 offen offset:0 nt lds
    buffer_load_dwordx4 v16, s[64:67], s8 offen offset:1024 nt lds
    buffer_load_dwordx4 v15, s[64:67], s8 offen offset:2048 nt lds
    buffer_load_dwordx4 v16, s[64:67], s8 offen offset:3072 nt lds
    s_add_u32 m0, s4, 12288
    s_add_u32 s8, s53, 4096
    buffer_load_dwordx4 v15, s[64:67], s8 offen offset:0 nt lds
    buffer_load_dwordx4 v16, s[64:67], s8 offen offset:1024 nt lds
    buffer_load_dwordx4 v15, s[64:67], s8 offen offset:2048 nt lds
    buffer_load_dwordx4 v16, s[64:67], s8 offen offset:3072 nt lds
    s_nop 7
    v_cvt_pk_bf16_f32 v5, v168, v169
    v_lshlrev_b32 v168, 16, v5
    v_and_b32 v169, s6, v5
    v_mul_f32 v168, s5, v168
    v_mul_f32 v169, s5, v169
    v_cvt_pk_bf16_f32 v5, v168, v169
    v_lshlrev_b32 v168, 16, v5
    v_and_b32 v169, s6, v5
    v_max3_f32 v36, v168, v169, v36
    v_cvt_pk_bf16_f32 v5, v170, v171
    v_lshlrev_b32 v170, 16, v5
    v_and_b32 v171, s6, v5
    v_mul_f32 v170, s5, v170
    v_mul_f32 v171, s5, v171
    v_cvt_pk_bf16_f32 v5, v170, v171
    v_lshlrev_b32 v170, 16, v5
    v_and_b32 v171, s6, v5
    v_max3_f32 v36, v170, v171, v36
    v_cvt_pk_bf16_f32 v5, v172, v173
    v_lshlrev_b32 v172, 16, v5
    v_and_b32 v173, s6, v5
    v_mul_f32 v172, s5, v172
    v_mul_f32 v173, s5, v173
    v_cvt_pk_bf16_f32 v5, v172, v173
    v_lshlrev_b32 v172, 16, v5
    v_and_b32 v173, s6, v5
    v_max3_f32 v36, v172, v173, v36
    v_cvt_pk_bf16_f32 v5, v174, v175
    v_lshlrev_b32 v174, 16, v5
    v_and_b32 v175, s6, v5
    v_mul_f32 v174, s5, v174
    v_mul_f32 v175, s5, v175
    v_cvt_pk_bf16_f32 v5, v174, v175
    v_lshlrev_b32 v174, 16, v5
    v_and_b32 v175, s6, v5
    v_max3_f32 v36, v174, v175, v36
    v_mov_b32 v5, v36
    s_nop 1
    v_permlane16_swap_b32 v36, v5
    v_max_f32 v36, v36, v5
    v_mov_b32 v5, v36
    s_nop 1
    v_permlane32_swap_b32 v36, v5
    v_max_f32 v36, v36, v5
    s_mov_b32 s7, 0x3fb8aa3b
    v_mul_f32 v38, s7, v36
    v_mov_b32 v37, 0
    v_mov_b32 v39, 0
    v_fma_f32 v120, v120, s7, -v38
    v_fma_f32 v121, v121, s7, -v38
    v_exp_f32 v120, v120
    v_exp_f32 v121, v121
    s_nop 0
    v_add_f32 v37, v37, v120
    v_add_f32 v39, v39, v121
    v_cvt_pk_bf16_f32 v120, v120, v121
    v_fma_f32 v122, v122, s7, -v38
    v_fma_f32 v123, v123, s7, -v38
    v_exp_f32 v122, v122
    v_exp_f32 v123, v123
    s_nop 0
    v_add_f32 v37, v37, v122
    v_add_f32 v39, v39, v123
    v_cvt_pk_bf16_f32 v121, v122, v123
    v_fma_f32 v124, v124, s7, -v38
    v_fma_f32 v125, v125, s7, -v38
    v_exp_f32 v124, v124
    v_exp_f32 v125, v125
    s_nop 0
    v_add_f32 v37, v37, v124
    v_add_f32 v39, v39, v125
    v_cvt_pk_bf16_f32 v122, v124, v125
    v_fma_f32 v126, v126, s7, -v38
    v_fma_f32 v127, v127, s7, -v38
    v_exp_f32 v126, v126
    v_exp_f32 v127, v127
    s_nop 0
    v_add_f32 v37, v37, v126
    v_add_f32 v39, v39, v127
    v_cvt_pk_bf16_f32 v123, v126, v127
    v_fma_f32 v128, v128, s7, -v38
    v_fma_f32 v129, v129, s7, -v38
    v_exp_f32 v128, v128
    v_exp_f32 v129, v129
    s_nop 0
    v_add_f32 v37, v37, v128
    v_add_f32 v39, v39, v129
    v_cvt_pk_bf16_f32 v128, v128, v129
    v_fma_f32 v130, v130, s7, -v38
    v_fma_f32 v131, v131, s7, -v38
    v_exp_f32 v130, v130
    v_exp_f32 v131, v131
    s_nop 0
    v_add_f32 v37, v37, v130
    v_add_f32 v39, v39, v131
    v_cvt_pk_bf16_f32 v129, v130, v131
    v_fma_f32 v132, v132, s7, -v38
    v_fma_f32 v133, v133, s7, -v38
    v_exp_f32 v132, v132
    v_exp_f32 v133, v133
    s_nop 0
    v_add_f32 v37, v37, v132
    v_add_f32 v39, v39, v133
    v_cvt_pk_bf16_f32 v130, v132, v133
    v_fma_f32 v134, v134, s7, -v38
    v_fma_f32 v135, v135, s7, -v38
    v_exp_f32 v134, v134
    v_exp_f32 v135, v135
    s_nop 0
    v_add_f32 v37, v37, v134
    v_add_f32 v39, v39, v135
    v_cvt_pk_bf16_f32 v131, v134, v135
    v_fma_f32 v136, v136, s7, -v38
    v_fma_f32 v137, v137, s7, -v38
    v_exp_f32 v136, v136
    v_exp_f32 v137, v137
    s_nop 0
    v_add_f32 v37, v37, v136
    v_add_f32 v39, v39, v137
    v_cvt_pk_bf16_f32 v136, v136, v137
    v_fma_f32 v138, v138, s7, -v38
    v_fma_f32 v139, v139, s7, -v38
    v_exp_f32 v138, v138
    v_exp_f32 v139, v139
    s_nop 0
    v_add_f32 v37, v37, v138
    v_add_f32 v39, v39, v139
    v_cvt_pk_bf16_f32 v137, v138, v139
    v_fma_f32 v140, v140, s7, -v38
    v_fma_f32 v141, v141, s7, -v38
    v_exp_f32 v140, v140
    v_exp_f32 v141, v141
    s_nop 0
    v_add_f32 v37, v37, v140
    v_add_f32 v39, v39, v141
    v_cvt_pk_bf16_f32 v138, v140, v141
    v_fma_f32 v142, v142, s7, -v38
    v_fma_f32 v143, v143, s7, -v38
    v_exp_f32 v142, v142
    v_exp_f32 v143, v143
    s_nop 0
    v_add_f32 v37, v37, v142
    v_add_f32 v39, v39, v143
    v_cvt_pk_bf16_f32 v139, v142, v143
    v_fma_f32 v144, v144, s7, -v38
    v_fma_f32 v145, v145, s7, -v38
    v_exp_f32 v144, v144
    v_exp_f32 v145, v145
    s_nop 0
    v_add_f32 v37, v37, v144
    v_add_f32 v39, v39, v145
    v_cvt_pk_bf16_f32 v144, v144, v145
    v_fma_f32 v146, v146, s7, -v38
    v_fma_f32 v147, v147, s7, -v38
    v_exp_f32 v146, v146
    v_exp_f32 v147, v147
    s_nop 0
    v_add_f32 v37, v37, v146
    v_add_f32 v39, v39, v147
    v_cvt_pk_bf16_f32 v145, v146, v147
    v_fma_f32 v148, v148, s7, -v38
    v_fma_f32 v149, v149, s7, -v38
    v_exp_f32 v148, v148
    v_exp_f32 v149, v149
    s_nop 0
    v_add_f32 v37, v37, v148
    v_add_f32 v39, v39, v149
    v_cvt_pk_bf16_f32 v146, v148, v149
    v_fma_f32 v150, v150, s7, -v38
    v_fma_f32 v151, v151, s7, -v38
    v_exp_f32 v150, v150
    v_exp_f32 v151, v151
    s_nop 0
    v_add_f32 v37, v37, v150
    v_add_f32 v39, v39, v151
    v_cvt_pk_bf16_f32 v147, v150, v151
    v_fma_f32 v152, v152, s7, -v38
    v_fma_f32 v153, v153, s7, -v38
    v_exp_f32 v152, v152
    v_exp_f32 v153, v153
    s_nop 0
    v_add_f32 v37, v37, v152
    v_add_f32 v39, v39, v153
    v_cvt_pk_bf16_f32 v152, v152, v153
    v_fma_f32 v154, v154, s7, -v38
    v_fma_f32 v155, v155, s7, -v38
    v_exp_f32 v154, v154
    v_exp_f32 v155, v155
    s_nop 0
    v_add_f32 v37, v37, v154
    v_add_f32 v39, v39, v155
    v_cvt_pk_bf16_f32 v153, v154, v155
    v_fma_f32 v156, v156, s7, -v38
    v_fma_f32 v157, v157, s7, -v38
    v_exp_f32 v156, v156
    v_exp_f32 v157, v157
    s_nop 0
    v_add_f32 v37, v37, v156
    v_add_f32 v39, v39, v157
    v_cvt_pk_bf16_f32 v154, v156, v157
    v_fma_f32 v158, v158, s7, -v38
    v_fma_f32 v159, v159, s7, -v38
    v_exp_f32 v158, v158
    v_exp_f32 v159, v159
    s_nop 0
    v_add_f32 v37, v37, v158
    v_add_f32 v39, v39, v159
    v_cvt_pk_bf16_f32 v155, v158, v159
    v_fma_f32 v160, v160, s7, -v38
    v_fma_f32 v161, v161, s7, -v38
    v_exp_f32 v160, v160
    v_exp_f32 v161, v161
    s_nop 0
    v_add_f32 v37, v37, v160
    v_add_f32 v39, v39, v161
    v_cvt_pk_bf16_f32 v160, v160, v161
    v_fma_f32 v162, v162, s7, -v38
    v_fma_f32 v163, v163, s7, -v38
    v_exp_f32 v162, v162
    v_exp_f32 v163, v163
    s_nop 0
    v_add_f32 v37, v37, v162
    v_add_f32 v39, v39, v163
    v_cvt_pk_bf16_f32 v161, v162, v163
    v_fma_f32 v164, v164, s7, -v38
    v_fma_f32 v165, v165, s7, -v38
    v_exp_f32 v164, v164
    v_exp_f32 v165, v165
    s_nop 0
    v_add_f32 v37, v37, v164
    v_add_f32 v39, v39, v165
    v_cvt_pk_bf16_f32 v162, v164, v165
    v_fma_f32 v166, v166, s7, -v38
    v_fma_f32 v167, v167, s7, -v38
    v_exp_f32 v166, v166
    v_exp_f32 v167, v167
    s_nop 0
    v_add_f32 v37, v37, v166
    v_add_f32 v39, v39, v167
    v_cvt_pk_bf16_f32 v163, v166, v167
    v_fma_f32 v168, v168, s7, -v38
    v_fma_f32 v169, v169, s7, -v38
    v_exp_f32 v168, v168
    v_exp_f32 v169, v169
    s_nop 0
    v_add_f32 v37, v37, v168
    v_add_f32 v39, v39, v169
    v_cvt_pk_bf16_f32 v168, v168, v169
    v_fma_f32 v170, v170, s7, -v38
    v_fma_f32 v171, v171, s7, -v38
    v_exp_f32 v170, v170
    v_exp_f32 v171, v171
    s_nop 0
    v_add_f32 v37, v37, v170
    v_add_f32 v39, v39, v171
    v_cvt_pk_bf16_f32 v169, v170, v171
    v_fma_f32 v172, v172, s7, -v38
    v_fma_f32 v173, v173, s7, -v38
    v_exp_f32 v172, v172
    v_exp_f32 v173, v173
    s_nop 0
    v_add_f32 v37, v37, v172
    v_add_f32 v39, v39, v173
    v_cvt_pk_bf16_f32 v170, v172, v173
    v_fma_f32 v174, v174, s7, -v38
    v_fma_f32 v175, v175, s7, -v38
    v_exp_f32 v174, v174
    v_exp_f32 v175, v175
    s_nop 0
    v_add_f32 v37, v37, v174
    v_add_f32 v39, v39, v175
    v_cvt_pk_bf16_f32 v171, v174, v175
    v_add_f32 v37, v37, v39
    ds_read_b64_tr_b16 v[56:57], v25 offset:16384
    ds_read_b64_tr_b16 v[58:59], v25 offset:20480
    ds_read_b64_tr_b16 v[60:61], v26 offset:16384
    ds_read_b64_tr_b16 v[62:63], v26 offset:20480
    ds_read_b64_tr_b16 v[64:65], v27 offset:16384
    ds_read_b64_tr_b16 v[66:67], v27 offset:20480
    ds_read_b64_tr_b16 v[68:69], v28 offset:16384
    ds_read_b64_tr_b16 v[70:71], v28 offset:20480
    ds_read_b64_tr_b16 v[72:73], v29 offset:16384
    ds_read_b64_tr_b16 v[74:75], v29 offset:20480
    ds_read_b64_tr_b16 v[76:77], v30 offset:16384
    ds_read_b64_tr_b16 v[78:79], v30 offset:20480
    ds_read_b64_tr_b16 v[80:81], v31 offset:16384
    ds_read_b64_tr_b16 v[82:83], v31 offset:20480
    ds_read_b64_tr_b16 v[84:85], v32 offset:16384
    ds_read_b64_tr_b16 v[86:87], v32 offset:20480
    s_waitcnt lgkmcnt(12)
    v_mfma_f32_16x16x32_bf16 v[88:91], v[56:59], v[120:123], 0
    v_mfma_f32_16x16x32_bf16 v[92:95], v[60:63], v[120:123], 0
    s_waitcnt lgkmcnt(8)
    v_mfma_f32_16x16x32_bf16 v[96:99], v[64:67], v[120:123], 0
    v_mfma_f32_16x16x32_bf16 v[100:103], v[68:71], v[120:123], 0
    s_waitcnt lgkmcnt(4)
    v_mfma_f32_16x16x32_bf16 v[104:107], v[72:75], v[120:123], 0
    v_mfma_f32_16x16x32_bf16 v[108:111], v[76:79], v[120:123], 0
    s_waitcnt lgkmcnt(0)
    v_mfma_f32_16x16x32_bf16 v[112:115], v[80:83], v[120:123], 0
    v_mfma_f32_16x16x32_bf16 v[116:119], v[84:87], v[120:123], 0
    s_waitcnt vmcnt(0)
    s_add_u32 m0, s4, 16384
    s_add_u32 s8, s54, 0
    buffer_load_dwordx4 v15, s[64:67], s8 offen offset:0 nt lds
    buffer_load_dwordx4 v16, s[64:67], s8 offen offset:1024 nt lds
    buffer_load_dwordx4 v15, s[64:67], s8 offen offset:2048 nt lds
    buffer_load_dwordx4 v16, s[64:67], s8 offen offset:3072 nt lds
    s_add_u32 m0, s4, 20480
    s_add_u32 s8, s54, 4096
    buffer_load_dwordx4 v15, s[64:67], s8 offen offset:0 nt lds
    buffer_load_dwordx4 v16, s[64:67], s8 offen offset:1024 nt lds
    buffer_load_dwordx4 v15, s[64:67], s8 offen offset:2048 nt lds
    buffer_load_dwordx4 v16, s[64:67], s8 offen offset:3072 nt lds
    ds_read_b64_tr_b16 v[56:57], v25 offset:24576
    ds_read_b64_tr_b16 v[58:59], v25 offset:28672
    ds_read_b64_tr_b16 v[60:61], v26 offset:24576
    ds_read_b64_tr_b16 v[62:63], v26 offset:28672
    ds_read_b64_tr_b16 v[64:65], v27 offset:24576
    ds_read_b64_tr_b16 v[66:67], v27 offset:28672
    ds_read_b64_tr_b16 v[68:69], v28 offset:24576
    ds_read_b64_tr_b16 v[70:71], v28 offset:28672
    ds_read_b64_tr_b16 v[72:73], v29 offset:24576
    ds_read_b64_tr_b16 v[74:75], v29 offset:28672
    ds_read_b64_tr_b16 v[76:77], v30 offset:24576
    ds_read_b64_tr_b16 v[78:79], v30 offset:28672
    ds_read_b64_tr_b16 v[80:81], v31 offset:24576
    ds_read_b64_tr_b16 v[82:83], v31 offset:28672
    ds_read_b64_tr_b16 v[84:85], v32 offset:24576
    ds_read_b64_tr_b16 v[86:87], v32 offset:28672
    s_waitcnt lgkmcnt(12)
    v_mfma_f32_16x16x32_bf16 v[88:91], v[56:59], v[128:131], v[88:91]
    v_mfma_f32_16x16x32_bf16 v[92:95], v[60:63], v[128:131], v[92:95]
    s_waitcnt lgkmcnt(8)
    v_mfma_f32_16x16x32_bf16 v[96:99], v[64:67], v[128:131], v[96:99]
    v_mfma_f32_16x16x32_bf16 v[100:103], v[68:71], v[128:131], v[100:103]
    s_waitcnt lgkmcnt(4)
    v_mfma_f32_16x16x32_bf16 v[104:107], v[72:75], v[128:131], v[104:107]
    v_mfma_f32_16x16x32_bf16 v[108:111], v[76:79], v[128:131], v[108:111]
    s_waitcnt lgkmcnt(0)
    v_mfma_f32_16x16x32_bf16 v[112:115], v[80:83], v[128:131], v[112:115]
    v_mfma_f32_16x16x32_bf16 v[116:119], v[84:87], v[128:131], v[116:119]
    s_waitcnt vmcnt(0)
    s_add_u32 m0, s4, 24576
    s_add_u32 s8, s55, 0
    buffer_load_dwordx4 v15, s[64:67], s8 offen offset:0 nt lds
    buffer_load_dwordx4 v16, s[64:67], s8 offen offset:1024 nt lds
    buffer_load_dwordx4 v15, s[64:67], s8 offen offset:2048 nt lds
    buffer_load_dwordx4 v16, s[64:67], s8 offen offset:3072 nt lds
    s_add_u32 m0, s4, 28672
    s_add_u32 s8, s55, 4096
    buffer_load_dwordx4 v15, s[64:67], s8 offen offset:0 nt lds
    buffer_load_dwordx4 v16, s[64:67], s8 offen offset:1024 nt lds
    buffer_load_dwordx4 v15, s[64:67], s8 offen offset:2048 nt lds
    buffer_load_dwordx4 v16, s[64:67], s8 offen offset:3072 nt lds
    ds_read_b64_tr_b16 v[56:57], v25 offset:0
    ds_read_b64_tr_b16 v[58:59], v25 offset:4096
    ds_read_b64_tr_b16 v[60:61], v26 offset:0
    ds_read_b64_tr_b16 v[62:63], v26 offset:4096
    ds_read_b64_tr_b16 v[64:65], v27 offset:0
    ds_read_b64_tr_b16 v[66:67], v27 offset:4096
    ds_read_b64_tr_b16 v[68:69], v28 offset:0
    ds_read_b64_tr_b16 v[70:71], v28 offset:4096
    ds_read_b64_tr_b16 v[72:73], v29 offset:0
    ds_read_b64_tr_b16 v[74:75], v29 offset:4096
    ds_read_b64_tr_b16 v[76:77], v30 offset:0
    ds_read_b64_tr_b16 v[78:79], v30 offset:4096
    ds_read_b64_tr_b16 v[80:81], v31 offset:0
    ds_read_b64_tr_b16 v[82:83], v31 offset:4096
    ds_read_b64_tr_b16 v[84:85], v32 offset:0
    ds_read_b64_tr_b16 v[86:87], v32 offset:4096
    s_waitcnt lgkmcnt(12)
    v_mfma_f32_16x16x32_bf16 v[88:91], v[56:59], v[136:139], v[88:91]
    v_mfma_f32_16x16x32_bf16 v[92:95], v[60:63], v[136:139], v[92:95]
    s_waitcnt lgkmcnt(8)
    v_mfma_f32_16x16x32_bf16 v[96:99], v[64:67], v[136:139], v[96:99]
    v_mfma_f32_16x16x32_bf16 v[100:103], v[68:71], v[136:139], v[100:103]
    s_waitcnt lgkmcnt(4)
    v_mfma_f32_16x16x32_bf16 v[104:107], v[72:75], v[136:139], v[104:107]
    v_mfma_f32_16x16x32_bf16 v[108:111], v[76:79], v[136:139], v[108:111]
    s_waitcnt lgkmcnt(0)
    v_mfma_f32_16x16x32_bf16 v[112:115], v[80:83], v[136:139], v[112:115]
    v_mfma_f32_16x16x32_bf16 v[116:119], v[84:87], v[136:139], v[116:119]
    s_waitcnt vmcnt(0)
    s_add_u32 m0, s4, 0
    s_add_u32 s8, s32, 0
    buffer_load_dwordx4 v15, s[64:67], s8 offen offset:0 nt lds
    buffer_load_dwordx4 v16, s[64:67], s8 offen offset:1024 nt lds
    buffer_load_dwordx4 v15, s[64:67], s8 offen offset:2048 nt lds
    buffer_load_dwordx4 v16, s[64:67], s8 offen offset:3072 nt lds
    s_add_u32 m0, s4, 4096
    s_add_u32 s8, s32, 4096
    buffer_load_dwordx4 v15, s[64:67], s8 offen offset:0 nt lds
    buffer_load_dwordx4 v16, s[64:67], s8 offen offset:1024 nt lds
    buffer_load_dwordx4 v15, s[64:67], s8 offen offset:2048 nt lds
    buffer_load_dwordx4 v16, s[64:67], s8 offen offset:3072 nt lds
    v_mov_b32 v240, 1
    v_mov_b32 v242, 0
    s_mov_b64 exec, 1
    buffer_atomic_add v240, v242, s[92:95], s25 offen sc0 sc1
    s_mov_b64 exec, -1
    ds_read_b64_tr_b16 v[56:57], v25 offset:8192
    ds_read_b64_tr_b16 v[58:59], v25 offset:12288
    ds_read_b64_tr_b16 v[60:61], v26 offset:8192
    ds_read_b64_tr_b16 v[62:63], v26 offset:12288
    ds_read_b64_tr_b16 v[64:65], v27 offset:8192
    ds_read_b64_tr_b16 v[66:67], v27 offset:12288
    ds_read_b64_tr_b16 v[68:69], v28 offset:8192
    ds_read_b64_tr_b16 v[70:71], v28 offset:12288
    ds_read_b64_tr_b16 v[72:73], v29 offset:8192
    ds_read_b64_tr_b16 v[74:75], v29 offset:12288
    ds_read_b64_tr_b16 v[76:77], v30 offset:8192
    ds_read_b64_tr_b16 v[78:79], v30 offset:12288
    ds_read_b64_tr_b16 v[80:81], v31 offset:8192
    ds_read_b64_tr_b16 v[82:83], v31 offset:12288
    ds_read_b64_tr_b16 v[84:85], v32 offset:8192
    ds_read_b64_tr_b16 v[86:87], v32 offset:12288
    s_waitcnt lgkmcnt(12)
    v_mfma_f32_16x16x32_bf16 v[88:91], v[56:59], v[144:147], v[88:91]
    v_mfma_f32_16x16x32_bf16 v[92:95], v[60:63], v[144:147], v[92:95]
    s_waitcnt lgkmcnt(8)
    v_mfma_f32_16x16x32_bf16 v[96:99], v[64:67], v[144:147], v[96:99]
    v_mfma_f32_16x16x32_bf16 v[100:103], v[68:71], v[144:147], v[100:103]
    s_waitcnt lgkmcnt(4)
    v_mfma_f32_16x16x32_bf16 v[104:107], v[72:75], v[144:147], v[104:107]
    v_mfma_f32_16x16x32_bf16 v[108:111], v[76:79], v[144:147], v[108:111]
    s_waitcnt lgkmcnt(0)
    v_mfma_f32_16x16x32_bf16 v[112:115], v[80:83], v[144:147], v[112:115]
    v_mfma_f32_16x16x32_bf16 v[116:119], v[84:87], v[144:147], v[116:119]
    ds_read_b64_tr_b16 v[56:57], v25 offset:16384
    ds_read_b64_tr_b16 v[58:59], v25 offset:20480
    ds_read_b64_tr_b16 v[60:61], v26 offset:16384
    ds_read_b64_tr_b16 v[62:63], v26 offset:20480
    ds_read_b64_tr_b16 v[64:65], v27 offset:16384
    ds_read_b64_tr_b16 v[66:67], v27 offset:20480
    ds_read_b64_tr_b16 v[68:69], v28 offset:16384
    ds_read_b64_tr_b16 v[70:71], v28 offset:20480
    ds_read_b64_tr_b16 v[72:73], v29 offset:16384
    ds_read_b64_tr_b16 v[74:75], v29 offset:20480
    ds_read_b64_tr_b16 v[76:77], v30 offset:16384
    ds_read_b64_tr_b16 v[78:79], v30 offset:20480
    ds_read_b64_tr_b16 v[80:81], v31 offset:16384
    ds_read_b64_tr_b16 v[82:83], v31 offset:20480
    ds_read_b64_tr_b16 v[84:85], v32 offset:16384
    ds_read_b64_tr_b16 v[86:87], v32 offset:20480
    s_waitcnt lgkmcnt(12)
    v_mfma_f32_16x16x32_bf16 v[88:91], v[56:59], v[152:155], v[88:91]
    v_mfma_f32_16x16x32_bf16 v[92:95], v[60:63], v[152:155], v[92:95]
    s_waitcnt lgkmcnt(8)
    v_mfma_f32_16x16x32_bf16 v[96:99], v[64:67], v[152:155], v[96:99]
    v_mfma_f32_16x16x32_bf16 v[100:103], v[68:71], v[152:155], v[100:103]
    s_waitcnt lgkmcnt(4)
    v_mfma_f32_16x16x32_bf16 v[104:107], v[72:75], v[152:155], v[104:107]
    v_mfma_f32_16x16x32_bf16 v[108:111], v[76:79], v[152:155], v[108:111]
    s_waitcnt lgkmcnt(0)
    v_mfma_f32_16x16x32_bf16 v[112:115], v[80:83], v[152:155], v[112:115]
    v_mfma_f32_16x16x32_bf16 v[116:119], v[84:87], v[152:155], v[116:119]
    ds_read_b64_tr_b16 v[56:57], v25 offset:24576
    ds_read_b64_tr_b16 v[58:59], v25 offset:28672
    ds_read_b64_tr_b16 v[60:61], v26 offset:24576
    ds_read_b64_tr_b16 v[62:63], v26 offset:28672
    ds_read_b64_tr_b16 v[64:65], v27 offset:24576
    ds_read_b64_tr_b16 v[66:67], v27 offset:28672
    ds_read_b64_tr_b16 v[68:69], v28 offset:24576
    ds_read_b64_tr_b16 v[70:71], v28 offset:28672
    ds_read_b64_tr_b16 v[72:73], v29 offset:24576
    ds_read_b64_tr_b16 v[74:75], v29 offset:28672
    ds_read_b64_tr_b16 v[76:77], v30 offset:24576
    ds_read_b64_tr_b16 v[78:79], v30 offset:28672
    ds_read_b64_tr_b16 v[80:81], v31 offset:24576
    ds_read_b64_tr_b16 v[82:83], v31 offset:28672
    ds_read_b64_tr_b16 v[84:85], v32 offset:24576
    ds_read_b64_tr_b16 v[86:87], v32 offset:28672
    s_waitcnt lgkmcnt(12)
    v_mfma_f32_16x16x32_bf16 v[88:91], v[56:59], v[160:163], v[88:91]
    v_mfma_f32_16x16x32_bf16 v[92:95], v[60:63], v[160:163], v[92:95]
    s_waitcnt lgkmcnt(8)
    v_mfma_f32_16x16x32_bf16 v[96:99], v[64:67], v[160:163], v[96:99]
    v_mfma_f32_16x16x32_bf16 v[100:103], v[68:71], v[160:163], v[100:103]
    s_waitcnt lgkmcnt(4)
    v_mfma_f32_16x16x32_bf16 v[104:107], v[72:75], v[160:163], v[104:107]
    v_mfma_f32_16x16x32_bf16 v[108:111], v[76:79], v[160:163], v[108:111]
    s_waitcnt lgkmcnt(0)
    v_mfma_f32_16x16x32_bf16 v[112:115], v[80:83], v[160:163], v[112:115]
    v_mfma_f32_16x16x32_bf16 v[116:119], v[84:87], v[160:163], v[116:119]
    s_waitcnt vmcnt(1)
    ds_read_b64_tr_b16 v[56:57], v25 offset:0
    ds_read_b64_tr_b16 v[58:59], v25 offset:4096
    ds_read_b64_tr_b16 v[60:61], v26 offset:0
    ds_read_b64_tr_b16 v[62:63], v26 offset:4096
    ds_read_b64_tr_b16 v[64:65], v27 offset:0
    ds_read_b64_tr_b16 v[66:67], v27 offset:4096
    ds_read_b64_tr_b16 v[68:69], v28 offset:0
    ds_read_b64_tr_b16 v[70:71], v28 offset:4096
    ds_read_b64_tr_b16 v[72:73], v29 offset:0
    ds_read_b64_tr_b16 v[74:75], v29 offset:4096
    ds_read_b64_tr_b16 v[76:77], v30 offset:0
    ds_read_b64_tr_b16 v[78:79], v30 offset:4096
    ds_read_b64_tr_b16 v[80:81], v31 offset:0
    ds_read_b64_tr_b16 v[82:83], v31 offset:4096
    ds_read_b64_tr_b16 v[84:85], v32 offset:0
    ds_read_b64_tr_b16 v[86:87], v32 offset:4096
    s_waitcnt lgkmcnt(12)
    v_mfma_f32_16x16x32_bf16 v[88:91], v[56:59], v[168:171], v[88:91]
    v_mfma_f32_16x16x32_bf16 v[92:95], v[60:63], v[168:171], v[92:95]
    s_waitcnt lgkmcnt(8)
    v_mfma_f32_16x16x32_bf16 v[96:99], v[64:67], v[168:171], v[96:99]
    v_mfma_f32_16x16x32_bf16 v[100:103], v[68:71], v[168:171], v[100:103]
    s_waitcnt lgkmcnt(4)
    v_mfma_f32_16x16x32_bf16 v[104:107], v[72:75], v[168:171], v[104:107]
    v_mfma_f32_16x16x32_bf16 v[108:111], v[76:79], v[168:171], v[108:111]
    s_waitcnt lgkmcnt(0)
    v_mfma_f32_16x16x32_bf16 v[112:115], v[80:83], v[168:171], v[112:115]
    v_mfma_f32_16x16x32_bf16 v[116:119], v[84:87], v[168:171], v[116:119]
L_dyn:
    s_waitcnt vmcnt(0)
    v_readfirstlane_b32 s8, v240
    s_add_u32 s8, s8, 1
    s_cmp_ge_u32 s8, 32
    s_cbranch_scc1 L_dyn_exit
    s_lshl_b32 s8, s8, 13
    s_add_u32 s18, s8, s24
    s_add_u32 m0, s4, 8192
    s_add_u32 s8, s18, 0
    buffer_load_dwordx4 v17, s[60:63], s8 offen offset:0 nt lds
    buffer_load_dwordx4 v18, s[60:63], s8 offen offset:1024 nt lds
    buffer_load_dwordx4 v19, s[60:63], s8 offen offset:2048 nt lds
    buffer_load_dwordx4 v20, s[60:63], s8 offen offset:3072 nt lds
    s_add_u32 m0, s4, 12288
    s_add_u32 s8, s18, 4096
    buffer_load_dwordx4 v17, s[60:63], s8 offen offset:0 nt lds
    buffer_load_dwordx4 v18, s[60:63], s8 offen offset:1024 nt lds
    buffer_load_dwordx4 v19, s[60:63], s8 offen offset:2048 nt lds
    buffer_load_dwordx4 v20, s[60:63], s8 offen offset:3072 nt lds
    s_add_u32 m0, s4, 0
    s_add_u32 s8, s18, 0
    buffer_load_dwordx4 v15, s[64:67], s8 offen offset:0 nt lds
    buffer_load_dwordx4 v16, s[64:67], s8 offen offset:1024 nt lds
    buffer_load_dwordx4 v15, s[64:67], s8 offen offset:2048 nt lds
    buffer_load_dwordx4 v16, s[64:67], s8 offen offset:3072 nt lds
    s_add_u32 m0, s4, 4096
    s_add_u32 s8, s18, 4096
    buffer_load_dwordx4 v15, s[64:67], s8 offen offset:0 nt lds
    buffer_load_dwordx4 v16, s[64:67], s8 offen offset:1024 nt lds
    buffer_load_dwordx4 v15, s[64:67], s8 offen offset:2048 nt lds
    buffer_load_dwordx4 v16, s[64:67], s8 offen offset:3072 nt lds
    s_waitcnt vmcnt(8)
    v_mov_b32 v240, 1
    v_mov_b32 v242, 0
    s_mov_b64 exec, 1
    buffer_atomic_add v240, v242, s[92:95], s25 offen sc0 sc1
    s_mov_b64 exec, -1
    ds_read_b128 v[56:59], v21 offset:8192
    ds_read_b128 v[60:63], v22 offset:8192
    ds_read_b128 v[64:67], v23 offset:8192
    ds_read_b128 v[68:71], v24 offset:8192
    ds_read_b128 v[72:75], v21 offset:12288
    ds_read_b128 v[76:79], v22 offset:12288
    ds_read_b128 v[80:83], v23 offset:12288
    ds_read_b128 v[84:87], v24 offset:12288
    s_waitcnt lgkmcnt(4)
    v_mfma_f32_16x16x32_bf16 v[168:171], v[56:59], v[40:43], 0
    v_mfma_f32_16x16x32_bf16 v[168:171], v[60:63], v[44:47], v[168:171]
    v_mfma_f32_16x16x32_bf16 v[168:171], v[64:67], v[48:51], v[168:171]
    v_mfma_f32_16x16x32_bf16 v[168:171], v[68:71], v[52:55], v[168:171]
    s_waitcnt lgkmcnt(0)
    v_mfma_f32_16x16x32_bf16 v[172:175], v[72:75], v[40:43], 0
    v_mfma_f32_16x16x32_bf16 v[172:175], v[76:79], v[44:47], v[172:175]
    v_mfma_f32_16x16x32_bf16 v[172:175], v[80:83], v[48:51], v[172:175]
    v_mfma_f32_16x16x32_bf16 v[172:175], v[84:87], v[52:55], v[172:175]
    s_nop 7
    v_cvt_pk_bf16_f32 v5, v168, v169
    v_lshlrev_b32 v168, 16, v5
    v_and_b32 v169, s6, v5
    v_mul_f32 v168, s5, v168
    v_mul_f32 v169, s5, v169
    v_cvt_pk_bf16_f32 v5, v168, v169
    v_lshlrev_b32 v168, 16, v5
    v_and_b32 v169, s6, v5
    v_max3_f32 v36, v168, v169, v36
    v_cvt_pk_bf16_f32 v5, v170, v171
    v_lshlrev_b32 v170, 16, v5
    v_and_b32 v171, s6, v5
    v_mul_f32 v170, s5, v170
    v_mul_f32 v171, s5, v171
    v_cvt_pk_bf16_f32 v5, v170, v171
    v_lshlrev_b32 v170, 16, v5
    v_and_b32 v171, s6, v5
    v_max3_f32 v36, v170, v171, v36
    v_cvt_pk_bf16_f32 v5, v172, v173
    v_lshlrev_b32 v172, 16, v5
    v_and_b32 v173, s6, v5
    v_mul_f32 v172, s5, v172
    v_mul_f32 v173, s5, v173
    v_cvt_pk_bf16_f32 v5, v172, v173
    v_lshlrev_b32 v172, 16, v5
    v_and_b32 v173, s6, v5
    v_max3_f32 v36, v172, v173, v36
    v_cvt_pk_bf16_f32 v5, v174, v175
    v_lshlrev_b32 v174, 16, v5
    v_and_b32 v175, s6, v5
    v_mul_f32 v174, s5, v174
    v_mul_f32 v175, s5, v175
    v_cvt_pk_bf16_f32 v5, v174, v175
    v_lshlrev_b32 v174, 16, v5
    v_and_b32 v175, s6, v5
    v_max3_f32 v36, v174, v175, v36
    v_mov_b32 v5, v36
    s_nop 1
    v_permlane16_swap_b32 v36, v5
    v_max_f32 v36, v36, v5
    v_mov_b32 v5, v36
    s_nop 1
    v_permlane32_swap_b32 v36, v5
    v_max_f32 v36, v36, v5
    v_mul_f32 v39, s7, v36
    v_sub_f32 v241, v38, v39
    v_exp_f32 v241, v241
    v_mov_b32 v38, v39
    v_mov_b32 v39, 0
    v_mul_f32 v37, v37, v241
    v_mul_f32 v88, v88, v241
    v_mul_f32 v89, v89, v241
    v_mul_f32 v90, v90, v241
    v_mul_f32 v91, v91, v241
    v_mul_f32 v92, v92, v241
    v_mul_f32 v93, v93, v241
    v_mul_f32 v94, v94, v241
    v_mul_f32 v95, v95, v241
    v_mul_f32 v96, v96, v241
    v_mul_f32 v97, v97, v241
    v_mul_f32 v98, v98, v241
    v_mul_f32 v99, v99, v241
    v_mul_f32 v100, v100, v241
    v_mul_f32 v101, v101, v241
    v_mul_f32 v102, v102, v241
    v_mul_f32 v103, v103, v241
    v_mul_f32 v104, v104, v241
    v_mul_f32 v105, v105, v241
    v_mul_f32 v106, v106, v241
    v_mul_f32 v107, v107, v241
    v_mul_f32 v108, v108, v241
    v_mul_f32 v109, v109, v241
    v_mul_f32 v110, v110, v241
    v_mul_f32 v111, v111, v241
    v_mul_f32 v112, v112, v241
    v_mul_f32 v113, v113, v241
    v_mul_f32 v114, v114, v241
    v_mul_f32 v115, v115, v241
    v_mul_f32 v116, v116, v241
    v_mul_f32 v117, v117, v241
    v_mul_f32 v118, v118, v241
    v_mul_f32 v119, v119, v241
    v_fma_f32 v168, v168, s7, -v38
    v_fma_f32 v169, v169, s7, -v38
    v_exp_f32 v168, v168
    v_exp_f32 v169, v169
    s_nop 0
    v_add_f32 v37, v37, v168
    v_add_f32 v39, v39, v169
    v_cvt_pk_bf16_f32 v168, v168, v169
    v_fma_f32 v170, v170, s7, -v38
    v_fma_f32 v171, v171, s7, -v38
    v_exp_f32 v170, v170
    v_exp_f32 v171, v171
    s_nop 0
    v_add_f32 v37, v37, v170
    v_add_f32 v39, v39, v171
    v_cvt_pk_bf16_f32 v169, v170, v171
    v_fma_f32 v172, v172, s7, -v38
    v_fma_f32 v173, v173, s7, -v38
    v_exp_f32 v172, v172
    v_exp_f32 v173, v173
    s_nop 0
    v_add_f32 v37, v37, v172
    v_add_f32 v39, v39, v173
    v_cvt_pk_bf16_f32 v170, v172, v173
    v_fma_f32 v174, v174, s7, -v38
    v_fma_f32 v175, v175, s7, -v38
    v_exp_f32 v174, v174
    v_exp_f32 v175, v175
    s_nop 0
    v_add_f32 v37, v37, v174
    v_add_f32 v39, v39, v175
    v_cvt_pk_bf16_f32 v171, v174, v175
    v_add_f32 v37, v37, v39
    s_waitcnt vmcnt(1)
    ds_read_b64_tr_b16 v[56:57], v25 offset:0
    ds_read_b64_tr_b16 v[58:59], v25 offset:4096
    ds_read_b64_tr_b16 v[60:61], v26 offset:0
    ds_read_b64_tr_b16 v[62:63], v26 offset:4096
    ds_read_b64_tr_b16 v[64:65], v27 offset:0
    ds_read_b64_tr_b16 v[66:67], v27 offset:4096
    ds_read_b64_tr_b16 v[68:69], v28 offset:0
    ds_read_b64_tr_b16 v[70:71], v28 offset:4096
    ds_read_b64_tr_b16 v[72:73], v29 offset:0
    ds_read_b64_tr_b16 v[74:75], v29 offset:4096
    ds_read_b64_tr_b16 v[76:77], v30 offset:0
    ds_read_b64_tr_b16 v[78:79], v30 offset:4096
    ds_read_b64_tr_b16 v[80:81], v31 offset:0
    ds_read_b64_tr_b16 v[82:83], v31 offset:4096
    ds_read_b64_tr_b16 v[84:85], v32 offset:0
    ds_read_b64_tr_b16 v[86:87], v32 offset:4096
    s_waitcnt lgkmcnt(12)
    v_mfma_f32_16x16x32_bf16 v[88:91], v[56:59], v[168:171], v[88:91]
    v_mfma_f32_16x16x32_bf16 v[92:95], v[60:63], v[168:171], v[92:95]
    s_waitcnt lgkmcnt(8)
    v_mfma_f32_16x16x32_bf16 v[96:99], v[64:67], v[168:171], v[96:99]
    v_mfma_f32_16x16x32_bf16 v[100:103], v[68:71], v[168:171], v[100:103]
    s_waitcnt lgkmcnt(4)
    v_mfma_f32_16x16x32_bf16 v[104:107], v[72:75], v[168:171], v[104:107]
    v_mfma_f32_16x16x32_bf16 v[108:111], v[76:79], v[168:171], v[108:111]
    s_waitcnt lgkmcnt(0)
    v_mfma_f32_16x16x32_bf16 v[112:115], v[80:83], v[168:171], v[112:115]
    v_mfma_f32_16x16x32_bf16 v[116:119], v[84:87], v[168:171], v[116:119]
    s_branch L_dyn
L_dyn_exit:
    s_add_u32 m0, s4, 16384
    s_add_u32 s8, s12, 0
    buffer_load_dwordx4 v13, s[80:83], s8 offen offset:0 nt lds
    s_add_u32 s8, s12, 7168
    buffer_load_dwordx4 v14, s[80:83], s8 offen offset:1024 nt lds
    s_add_u32 s8, s12, 14336
    buffer_load_dwordx4 v13, s[80:83], s8 offen offset:2048 nt lds
    s_add_u32 s8, s12, 21504
    buffer_load_dwordx4 v14, s[80:83], s8 offen offset:3072 nt lds
    s_add_u32 m0, s4, 20480
    s_add_u32 s8, s12, 32768
    buffer_load_dwordx4 v13, s[80:83], s8 offen offset:0 nt lds
    s_add_u32 s8, s12, 39936
    buffer_load_dwordx4 v14, s[80:83], s8 offen offset:1024 nt lds
    s_add_u32 s8, s12, 47104
    buffer_load_dwordx4 v13, s[80:83], s8 offen offset:2048 nt lds
    s_add_u32 s8, s12, 54272
    buffer_load_dwordx4 v14, s[80:83], s8 offen offset:3072 nt lds
    v_mov_b32 v5, v37
    s_nop 1
    v_permlane16_swap_b32 v37, v5
    v_add_f32 v37, v37, v5
    v_mov_b32 v5, v37
    s_nop 1
    v_permlane32_swap_b32 v37, v5
    v_add_f32 v37, v37, v5
    s_lshl_b32 s5, s3, 12
    v_add_u32 v6, s5, v34
    s_lshl_b32 s5, s3, 3
    v_lshlrev_b32 v5, 5, v2
    v_add_u32 v5, s5, v5
    s_nop 7
    s_mov_b32 exec_lo, 0xff00ff
    s_mov_b32 exec_hi, 0xff00ff
    ds_write_b128 v6, v[88:91] offset:14336
    ds_write_b128 v6, v[92:95] offset:14400
    ds_write_b128 v6, v[96:99] offset:14464
    ds_write_b128 v6, v[100:103] offset:14528
    ds_write_b128 v6, v[104:107] offset:14592
    ds_write_b128 v6, v[108:111] offset:14656
    ds_write_b128 v6, v[112:115] offset:14720
    ds_write_b128 v6, v[116:119] offset:14784
    s_mov_b32 exec_lo, 0xff
    s_mov_b32 exec_hi, 0x0
    ds_write_b64 v5, v[36:37] offset:30720
    s_mov_b64 exec, -1
    s_waitcnt lgkmcnt(0)
    s_barrier
    s_waitcnt vmcnt(0)
    s_add_u32 m0, s4, 24576
    s_add_u32 s8, s13, 0
    buffer_load_dwordx4 v13, s[72:75], s8 offen offset:0 nt lds
    s_add_u32 s8, s13, 7168
    buffer_load_dwordx4 v14, s[72:75], s8 offen offset:1024 nt lds
    s_add_u32 s8, s13, 14336
    buffer_load_dwordx4 v13, s[72:75], s8 offen offset:2048 nt lds
    s_add_u32 s8, s13, 21504
    buffer_load_dwordx4 v14, s[72:75], s8 offen offset:3072 nt lds
    s_add_u32 m0, s4, 28672
    s_add_u32 s8, s13, 32768
    buffer_load_dwordx4 v13, s[72:75], s8 offen offset:0 nt lds
    s_add_u32 s8, s13, 39936
    buffer_load_dwordx4 v14, s[72:75], s8 offen offset:1024 nt lds
    s_add_u32 s8, s13, 47104
    buffer_load_dwordx4 v13, s[72:75], s8 offen offset:2048 nt lds
    s_add_u32 s8, s13, 54272
    buffer_load_dwordx4 v14, s[72:75], s8 offen offset:3072 nt lds
    v_and_b32 v3, 1, v2
    v_lshlrev_b32 v4, 3, v1
    v_lshl_add_u32 v6, v3, 6, v4
    ds_read_b64 v[40:41], v6 offset:30976
    ds_read_b64 v[42:43], v6 offset:31008
    s_waitcnt lgkmcnt(0)
    ds_read_b64_tr_b16 v[56:57], v25 offset:16384
    ds_read_b64_tr_b16 v[58:59], v25 offset:20480
    ds_read_b64_tr_b16 v[60:61], v26 offset:16384
    ds_read_b64_tr_b16 v[62:63], v26 offset:20480
    ds_read_b64_tr_b16 v[64:65], v27 offset:16384
    ds_read_b64_tr_b16 v[66:67], v27 offset:20480
    ds_read_b64_tr_b16 v[68:69], v28 offset:16384
    ds_read_b64_tr_b16 v[70:71], v28 offset:20480
    ds_read_b64_tr_b16 v[72:73], v29 offset:16384
    ds_read_b64_tr_b16 v[74:75], v29 offset:20480
    ds_read_b64_tr_b16 v[76:77], v30 offset:16384
    ds_read_b64_tr_b16 v[78:79], v30 offset:20480
    ds_read_b64_tr_b16 v[80:81], v31 offset:16384
    ds_read_b64_tr_b16 v[82:83], v31 offset:20480
    ds_read_b64_tr_b16 v[84:85], v32 offset:16384
    ds_read_b64_tr_b16 v[86:87], v32 offset:20480
    s_waitcnt lgkmcnt(12)
    v_mfma_f32_16x16x32_bf16 v[88:91], v[56:59], v[40:43], 0
    v_mfma_f32_16x16x32_bf16 v[92:95], v[60:63], v[40:43], 0
    s_waitcnt lgkmcnt(8)
    v_mfma_f32_16x16x32_bf16 v[96:99], v[64:67], v[40:43], 0
    v_mfma_f32_16x16x32_bf16 v[100:103], v[68:71], v[40:43], 0
    s_waitcnt lgkmcnt(4)
    v_mfma_f32_16x16x32_bf16 v[104:107], v[72:75], v[40:43], 0
    v_mfma_f32_16x16x32_bf16 v[108:111], v[76:79], v[40:43], 0
    s_waitcnt lgkmcnt(0)
    v_mfma_f32_16x16x32_bf16 v[112:115], v[80:83], v[40:43], 0
    v_mfma_f32_16x16x32_bf16 v[116:119], v[84:87], v[40:43], 0
    s_nop 7
    v_min_u32 v88, 0xfffffffe, v88
    v_min_u32 v89, 0xfffffffe, v89
    v_min_u32 v90, 0xfffffffe, v90
    v_min_u32 v91, 0xfffffffe, v91
    v_min_u32 v92, 0xfffffffe, v92
    v_min_u32 v93, 0xfffffffe, v93
    v_min_u32 v94, 0xfffffffe, v94
    v_min_u32 v95, 0xfffffffe, v95
    v_min_u32 v96, 0xfffffffe, v96
    v_min_u32 v97, 0xfffffffe, v97
    v_min_u32 v98, 0xfffffffe, v98
    v_min_u32 v99, 0xfffffffe, v99
    v_min_u32 v100, 0xfffffffe, v100
    v_min_u32 v101, 0xfffffffe, v101
    v_min_u32 v102, 0xfffffffe, v102
    v_min_u32 v103, 0xfffffffe, v103
    v_min_u32 v104, 0xfffffffe, v104
    v_min_u32 v105, 0xfffffffe, v105
    v_min_u32 v106, 0xfffffffe, v106
    v_min_u32 v107, 0xfffffffe, v107
    v_min_u32 v108, 0xfffffffe, v108
    v_min_u32 v109, 0xfffffffe, v109
    v_min_u32 v110, 0xfffffffe, v110
    v_min_u32 v111, 0xfffffffe, v111
    v_min_u32 v112, 0xfffffffe, v112
    v_min_u32 v113, 0xfffffffe, v113
    v_min_u32 v114, 0xfffffffe, v114
    v_min_u32 v115, 0xfffffffe, v115
    v_min_u32 v116, 0xfffffffe, v116
    v_min_u32 v117, 0xfffffffe, v117
    v_min_u32 v118, 0xfffffffe, v118
    v_min_u32 v119, 0xfffffffe, v119
    s_lshr_b32 s5, s12, 16
    s_lshl_b32 s5, s5, 5
    s_and_b32 s6, s12, 0xffff
    s_lshl_b32 s6, s6, 9
    s_add_u32 s5, s5, s6
    s_add_u32 s5, s5, 3145728
    s_cmp_lt_u32 s2, 32
    s_cselect_b32 s5, 0x40000000, s5
    s_mov_b32 exec_lo, 0x30003
    s_mov_b32 exec_hi, 0x30003
    buffer_store_dwordx4 v[88:91], v35, s[92:95], s5 offen sc1
    s_add_u32 s5, s5, 16384
    buffer_store_dwordx4 v[92:95], v35, s[92:95], s5 offen sc1
    s_add_u32 s5, s5, 16384
    buffer_store_dwordx4 v[96:99], v35, s[92:95], s5 offen sc1
    s_add_u32 s5, s5, 16384
    buffer_store_dwordx4 v[100:103], v35, s[92:95], s5 offen sc1
    s_add_u32 s5, s5, 16384
    buffer_store_dwordx4 v[104:107], v35, s[92:95], s5 offen sc1
    s_add_u32 s5, s5, 16384
    buffer_store_dwordx4 v[108:111], v35, s[92:95], s5 offen sc1
    s_add_u32 s5, s5, 16384
    buffer_store_dwordx4 v[112:115], v35, s[92:95], s5 offen sc1
    s_add_u32 s5, s5, 16384
    buffer_store_dwordx4 v[116:119], v35, s[92:95], s5 offen sc1
    s_mov_b64 exec, -1
    s_barrier
    v_and_b32 v3, 1, v2
    v_lshlrev_b32 v4, 3, v1
    v_lshl_add_u32 v6, v3, 6, v4
    ds_read_b64 v[40:41], v6 offset:31104
    ds_read_b64 v[42:43], v6 offset:31136
    s_waitcnt lgkmcnt(0)
    s_waitcnt vmcnt(8)
    ds_read_b64_tr_b16 v[56:57], v25 offset:24576
    ds_read_b64_tr_b16 v[58:59], v25 offset:28672
    ds_read_b64_tr_b16 v[60:61], v26 offset:24576
    ds_read_b64_tr_b16 v[62:63], v26 offset:28672
    ds_read_b64_tr_b16 v[64:65], v27 offset:24576
    ds_read_b64_tr_b16 v[66:67], v27 offset:28672
    ds_read_b64_tr_b16 v[68:69], v28 offset:24576
    ds_read_b64_tr_b16 v[70:71], v28 offset:28672
    ds_read_b64_tr_b16 v[72:73], v29 offset:24576
    ds_read_b64_tr_b16 v[74:75], v29 offset:28672
    ds_read_b64_tr_b16 v[76:77], v30 offset:24576
    ds_read_b64_tr_b16 v[78:79], v30 offset:28672
    ds_read_b64_tr_b16 v[80:81], v31 offset:24576
    ds_read_b64_tr_b16 v[82:83], v31 offset:28672
    ds_read_b64_tr_b16 v[84:85], v32 offset:24576
    ds_read_b64_tr_b16 v[86:87], v32 offset:28672
    s_waitcnt lgkmcnt(12)
    v_mfma_f32_16x16x32_bf16 v[88:91], v[56:59], v[40:43], 0
    v_mfma_f32_16x16x32_bf16 v[92:95], v[60:63], v[40:43], 0
    s_waitcnt lgkmcnt(8)
    v_mfma_f32_16x16x32_bf16 v[96:99], v[64:67], v[40:43], 0
    v_mfma_f32_16x16x32_bf16 v[100:103], v[68:71], v[40:43], 0
    s_waitcnt lgkmcnt(4)
    v_mfma_f32_16x16x32_bf16 v[104:107], v[72:75], v[40:43], 0
    v_mfma_f32_16x16x32_bf16 v[108:111], v[76:79], v[40:43], 0
    s_waitcnt lgkmcnt(0)
    v_mfma_f32_16x16x32_bf16 v[112:115], v[80:83], v[40:43], 0
    v_mfma_f32_16x16x32_bf16 v[116:119], v[84:87], v[40:43], 0
    s_nop 7
    v_min_u32 v88, 0xfffffffe, v88
    v_min_u32 v89, 0xfffffffe, v89
    v_min_u32 v90, 0xfffffffe, v90
    v_min_u32 v91, 0xfffffffe, v91
    v_min_u32 v92, 0xfffffffe, v92
    v_min_u32 v93, 0xfffffffe, v93
    v_min_u32 v94, 0xfffffffe, v94
    v_min_u32 v95, 0xfffffffe, v95
    v_min_u32 v96, 0xfffffffe, v96
    v_min_u32 v97, 0xfffffffe, v97
    v_min_u32 v98, 0xfffffffe, v98
    v_min_u32 v99, 0xfffffffe, v99
    v_min_u32 v100, 0xfffffffe, v100
    v_min_u32 v101, 0xfffffffe, v101
    v_min_u32 v102, 0xfffffffe, v102
    v_min_u32 v103, 0xfffffffe, v103
    v_min_u32 v104, 0xfffffffe, v104
    v_min_u32 v105, 0xfffffffe, v105
    v_min_u32 v106, 0xfffffffe, v106
    v_min_u32 v107, 0xfffffffe, v107
    v_min_u32 v108, 0xfffffffe, v108
    v_min_u32 v109, 0xfffffffe, v109
    v_min_u32 v110, 0xfffffffe, v110
    v_min_u32 v111, 0xfffffffe, v111
    v_min_u32 v112, 0xfffffffe, v112
    v_min_u32 v113, 0xfffffffe, v113
    v_min_u32 v114, 0xfffffffe, v114
    v_min_u32 v115, 0xfffffffe, v115
    v_min_u32 v116, 0xfffffffe, v116
    v_min_u32 v117, 0xfffffffe, v117
    v_min_u32 v118, 0xfffffffe, v118
    v_min_u32 v119, 0xfffffffe, v119
    s_lshr_b32 s5, s13, 16
    s_lshl_b32 s5, s5, 5
    s_and_b32 s6, s13, 0xffff
    s_lshl_b32 s6, s6, 9
    s_add_u32 s5, s5, s6
    s_add_u32 s5, s5, 2097152
    s_mov_b32 exec_lo, 0x30003
    s_mov_b32 exec_hi, 0x30003
    buffer_store_dwordx4 v[88:91], v35, s[92:95], s5 offen sc1
    s_add_u32 s5, s5, 16384
    buffer_store_dwordx4 v[92:95], v35, s[92:95], s5 offen sc1
    s_add_u32 s5, s5, 16384
    buffer_store_dwordx4 v[96:99], v35, s[92:95], s5 offen sc1
    s_add_u32 s5, s5, 16384
    buffer_store_dwordx4 v[100:103], v35, s[92:95], s5 offen sc1
    s_add_u32 s5, s5, 16384
    buffer_store_dwordx4 v[104:107], v35, s[92:95], s5 offen sc1
    s_add_u32 s5, s5, 16384
    buffer_store_dwordx4 v[108:111], v35, s[92:95], s5 offen sc1
    s_add_u32 s5, s5, 16384
    buffer_store_dwordx4 v[112:115], v35, s[92:95], s5 offen sc1
    s_add_u32 s5, s5, 16384
    buffer_store_dwordx4 v[116:119], v35, s[92:95], s5 offen sc1
    s_mov_b64 exec, -1
    s_endpgm
L_helper:
    s_setprio 2
    s_sub_u32 s4, s3, 4
    s_and_b32 s5, s4, 1
    s_lshl_b32 s6, s5, 11
    v_lshlrev_b32 v2, 5, v0
    buffer_load_dwordx4 v[32:35], v2, s[56:59], s6 offen
    buffer_load_dwordx4 v[36:39], v2, s[56:59], s6 offen offset:16
    s_lshl_b32 s7, s2, 3
    v_and_b32 v3, 1, v0
    v_lshlrev_b32 v3, 11, v3
    buffer_load_dwordx2 v[8:9], v3, s[56:59], s7 offen
    s_lshl_b32 s7, s4, 6
    v_add_u32 v1, s7, v0
    v_mov_b32 v12, -1
    v_mov_b32 v13, -1
    v_mov_b32 v14, -1
    v_mov_b32 v15, -1
    v_mov_b32 v4, 0
    v_lshlrev_b32 v5, 2, v0
    v_and_b32 v5, 63, v5
    ds_write_b32 v5, v4 offset:31296
    v_lshlrev_b32 v3, 4, v1
    s_cmp_lg_u32 s2, 0
    s_cbranch_scc1 L_h_noboot
    s_mov_b32 s7, 1703936
    buffer_store_dwordx4 v[12:15], v3, s[92:95], s7 offen sc1
    s_mov_b32 s7, 1708032
    buffer_store_dwordx4 v[12:15], v3, s[92:95], s7 offen sc1
    s_mov_b32 s7, 1712128
    buffer_store_dwordx4 v[12:15], v3, s[92:95], s7 offen sc1
    s_mov_b32 s7, 1716224
    buffer_store_dwordx4 v[12:15], v3, s[92:95], s7 offen sc1
    s_waitcnt vmcnt(0)
    s_lshl_b32 s7, s4, 2
    v_mov_b32 v4, 1
    v_mov_b32 v5, 0
    s_mov_b64 exec, 1
    buffer_store_dword v4, v5, s[88:91], s7 offen sc1
    s_mov_b64 exec, -1
L_h_noboot:
    v_lshlrev_b32 v3, 4, v1
    s_lshl_b32 s7, s2, 12
    s_add_u32 s7, s7, 524288
    buffer_store_dwordx4 v[12:15], v3, s[92:95], s7 offen sc1
    s_lshl_b32 s7, s2, 12
    s_add_u32 s8, s7, 2097152
    buffer_store_dwordx4 v[12:15], v3, s[92:95], s8 offen sc1
    v_cmp_gt_u32 vcc, 224, v1
    s_nop 1
    v_cndmask_b32 v16, 0, v12, vcc
    v_cndmask_b32 v17, 0, v12, vcc
    v_cndmask_b32 v18, 0, v12, vcc
    v_cndmask_b32 v19, 0, v12, vcc
    s_add_u32 s8, s7, 3145728
    buffer_store_dwordx4 v[16:19], v3, s[92:95], s8 offen sc1
    s_cmp_lg_u32 s4, 0
    s_cbranch_scc1 L_h_skipml
    s_lshr_b32 s7, s2, 5
    s_lshl_b32 s7, s7, 11
    s_and_b32 s8, s2, 31
    s_lshl_b32 s8, s8, 3
    s_add_u32 s7, s7, s8
    s_add_u32 s7, s7, 1572864
    v_lshlrev_b32 v4, 8, v0
    s_mov_b32 exec_lo, 0xff
    s_mov_b32 exec_hi, 0x0
    buffer_store_dwordx2 v[12:13], v4, s[92:95], s7 offen sc1
    s_mov_b64 exec, -1
L_h_skipml:
    s_waitcnt vmcnt(3)
    s_mov_b32 s7, 0xffff0000
    v_lshlrev_b32 v16, 16, v32
    v_and_b32 v17, s7, v32
    v_lshlrev_b32 v18, 16, v33
    v_and_b32 v19, s7, v33
    v_lshlrev_b32 v20, 16, v34
    v_and_b32 v21, s7, v34
    v_lshlrev_b32 v22, 16, v35
    v_and_b32 v23, s7, v35
    v_lshlrev_b32 v24, 16, v36
    v_and_b32 v25, s7, v36
    v_lshlrev_b32 v26, 16, v37
    v_and_b32 v27, s7, v37
    v_lshlrev_b32 v28, 16, v38
    v_and_b32 v29, s7, v38
    v_lshlrev_b32 v30, 16, v39
    v_and_b32 v31, s7, v39
    v_add_f32 v2, v16, v17
    v_add_f32 v2, v2, v18
    v_add_f32 v2, v2, v19
    v_add_f32 v2, v2, v20
    v_add_f32 v2, v2, v21
    v_add_f32 v2, v2, v22
    v_add_f32 v2, v2, v23
    v_add_f32 v2, v2, v24
    v_add_f32 v2, v2, v25
    v_add_f32 v2, v2, v26
    v_add_f32 v2, v2, v27
    v_add_f32 v2, v2, v28
    v_add_f32 v2, v2, v29
    v_add_f32 v2, v2, v30
    v_add_f32 v2, v2, v31
    s_nop 1
    v_add_f32_dpp v2, v2, v2 quad_perm:[1,0,3,2] row_mask:0xf bank_mask:0xf
    s_nop 1
    v_add_f32_dpp v2, v2, v2 quad_perm:[2,3,0,1] row_mask:0xf bank_mask:0xf
    s_nop 1
    v_add_f32_dpp v2, v2, v2 row_half_mirror row_mask:0xf bank_mask:0xf
    s_nop 1
    v_add_f32_dpp v2, v2, v2 row_mirror row_mask:0xf bank_mask:0xf
    v_mov_b32 v3, v2
    s_nop 1
    v_permlane16_swap_b32 v2, v3
    v_add_f32 v2, v2, v3
    v_mov_b32 v3, v2
    s_nop 1
    v_permlane32_swap_b32 v2, v3
    v_add_f32 v2, v2, v3
    v_mul_f32 v2, 0x3a800000, v2
    v_mov_b32 v4, 0
    v_sub_f32 v5, v16, v2
    v_fmac_f32 v4, v5, v5
    v_sub_f32 v5, v17, v2
    v_fmac_f32 v4, v5, v5
    v_sub_f32 v5, v18, v2
    v_fmac_f32 v4, v5, v5
    v_sub_f32 v5, v19, v2
    v_fmac_f32 v4, v5, v5
    v_sub_f32 v5, v20, v2
    v_fmac_f32 v4, v5, v5
    v_sub_f32 v5, v21, v2
    v_fmac_f32 v4, v5, v5
    v_sub_f32 v5, v22, v2
    v_fmac_f32 v4, v5, v5
    v_sub_f32 v5, v23, v2
    v_fmac_f32 v4, v5, v5
    v_sub_f32 v5, v24, v2
    v_fmac_f32 v4, v5, v5
    v_sub_f32 v5, v25, v2
    v_fmac_f32 v4, v5, v5
    v_sub_f32 v5, v26, v2
    v_fmac_f32 v4, v5, v5
    v_sub_f32 v5, v27, v2
    v_fmac_f32 v4, v5, v5
    v_sub_f32 v5, v28, v2
    v_fmac_f32 v4, v5, v5
    v_sub_f32 v5, v29, v2
    v_fmac_f32 v4, v5, v5
    v_sub_f32 v5, v30, v2
    v_fmac_f32 v4, v5, v5
    v_sub_f32 v5, v31, v2
    v_fmac_f32 v4, v5, v5
    s_nop 1
    v_add_f32_dpp v4, v4, v4 quad_perm:[1,0,3,2] row_mask:0xf bank_mask:0xf
    s_nop 1
    v_add_f32_dpp v4, v4, v4 quad_perm:[2,3,0,1] row_mask:0xf bank_mask:0xf
    s_nop 1
    v_add_f32_dpp v4, v4, v4 row_half_mirror row_mask:0xf bank_mask:0xf
    s_nop 1
    v_add_f32_dpp v4, v4, v4 row_mirror row_mask:0xf bank_mask:0xf
    v_mov_b32 v3, v4
    s_nop 1
    v_permlane16_swap_b32 v4, v3
    v_add_f32 v4, v4, v3
    v_mov_b32 v3, v4
    s_nop 1
    v_permlane32_swap_b32 v4, v3
    v_add_f32 v4, v4, v3
    v_mul_f32 v4, 0x3a800000, v4
    v_cvt_pk_bf16_f32 v3, v2, v2
    v_lshlrev_b32 v2, 16, v3
    v_cvt_pk_bf16_f32 v3, v4, v4
    v_lshlrev_b32 v4, 16, v3
    v_add_f32 v4, 0x3727c5ac, v4
    v_cvt_pk_bf16_f32 v3, v4, v4
    v_lshlrev_b32 v4, 16, v3
    v_sqrt_f32 v4, v4
    s_nop 0
    v_cvt_pk_bf16_f32 v3, v4, v4
    v_lshlrev_b32 v4, 16, v3
    v_rcp_f32 v5, v4
    s_nop 0
    v_sub_f32 v16, v16, v2
    v_sub_f32 v17, v17, v2
    v_cvt_pk_bf16_f32 v3, v16, v17
    v_lshlrev_b32 v16, 16, v3
    v_and_b32 v17, s7, v3
    v_mul_f32 v6, v16, v5
    v_fma_f32 v16, -v6, v4, v16
    v_fma_f32 v16, v16, v5, v6
    v_mul_f32 v6, v17, v5
    v_fma_f32 v17, -v6, v4, v17
    v_fma_f32 v17, v17, v5, v6
    v_cvt_pk_bf16_f32 v32, v16, v17
    v_sub_f32 v18, v18, v2
    v_sub_f32 v19, v19, v2
    v_cvt_pk_bf16_f32 v3, v18, v19
    v_lshlrev_b32 v18, 16, v3
    v_and_b32 v19, s7, v3
    v_mul_f32 v6, v18, v5
    v_fma_f32 v18, -v6, v4, v18
    v_fma_f32 v18, v18, v5, v6
    v_mul_f32 v6, v19, v5
    v_fma_f32 v19, -v6, v4, v19
    v_fma_f32 v19, v19, v5, v6
    v_cvt_pk_bf16_f32 v33, v18, v19
    v_sub_f32 v20, v20, v2
    v_sub_f32 v21, v21, v2
    v_cvt_pk_bf16_f32 v3, v20, v21
    v_lshlrev_b32 v20, 16, v3
    v_and_b32 v21, s7, v3
    v_mul_f32 v6, v20, v5
    v_fma_f32 v20, -v6, v4, v20
    v_fma_f32 v20, v20, v5, v6
    v_mul_f32 v6, v21, v5
    v_fma_f32 v21, -v6, v4, v21
    v_fma_f32 v21, v21, v5, v6
    v_cvt_pk_bf16_f32 v34, v20, v21
    v_sub_f32 v22, v22, v2
    v_sub_f32 v23, v23, v2
    v_cvt_pk_bf16_f32 v3, v22, v23
    v_lshlrev_b32 v22, 16, v3
    v_and_b32 v23, s7, v3
    v_mul_f32 v6, v22, v5
    v_fma_f32 v22, -v6, v4, v22
    v_fma_f32 v22, v22, v5, v6
    v_mul_f32 v6, v23, v5
    v_fma_f32 v23, -v6, v4, v23
    v_fma_f32 v23, v23, v5, v6
    v_cvt_pk_bf16_f32 v35, v22, v23
    v_sub_f32 v24, v24, v2
    v_sub_f32 v25, v25, v2
    v_cvt_pk_bf16_f32 v3, v24, v25
    v_lshlrev_b32 v24, 16, v3
    v_and_b32 v25, s7, v3
    v_mul_f32 v6, v24, v5
    v_fma_f32 v24, -v6, v4, v24
    v_fma_f32 v24, v24, v5, v6
    v_mul_f32 v6, v25, v5
    v_fma_f32 v25, -v6, v4, v25
    v_fma_f32 v25, v25, v5, v6
    v_cvt_pk_bf16_f32 v36, v24, v25
    v_sub_f32 v26, v26, v2
    v_sub_f32 v27, v27, v2
    v_cvt_pk_bf16_f32 v3, v26, v27
    v_lshlrev_b32 v26, 16, v3
    v_and_b32 v27, s7, v3
    v_mul_f32 v6, v26, v5
    v_fma_f32 v26, -v6, v4, v26
    v_fma_f32 v26, v26, v5, v6
    v_mul_f32 v6, v27, v5
    v_fma_f32 v27, -v6, v4, v27
    v_fma_f32 v27, v27, v5, v6
    v_cvt_pk_bf16_f32 v37, v26, v27
    v_sub_f32 v28, v28, v2
    v_sub_f32 v29, v29, v2
    v_cvt_pk_bf16_f32 v3, v28, v29
    v_lshlrev_b32 v28, 16, v3
    v_and_b32 v29, s7, v3
    v_mul_f32 v6, v28, v5
    v_fma_f32 v28, -v6, v4, v28
    v_fma_f32 v28, v28, v5, v6
    v_mul_f32 v6, v29, v5
    v_fma_f32 v29, -v6, v4, v29
    v_fma_f32 v29, v29, v5, v6
    v_cvt_pk_bf16_f32 v38, v28, v29
    v_sub_f32 v30, v30, v2
    v_sub_f32 v31, v31, v2
    v_cvt_pk_bf16_f32 v3, v30, v31
    v_lshlrev_b32 v30, 16, v3
    v_and_b32 v31, s7, v3
    v_mul_f32 v6, v30, v5
    v_fma_f32 v30, -v6, v4, v30
    v_fma_f32 v30, v30, v5, v6
    v_mul_f32 v6, v31, v5
    v_fma_f32 v31, -v6, v4, v31
    v_fma_f32 v31, v31, v5, v6
    v_cvt_pk_bf16_f32 v39, v30, v31
    v_lshlrev_b32 v2, 5, v0
    v_add_u32 v2, s6, v2
    ds_write_b128 v2, v[32:35] offset:0
    ds_write_b128 v2, v[36:39] offset:16
    s_waitcnt lgkmcnt(0)
    s_barrier
    s_barrier
    s_cmp_lg_u32 s4, 0
    s_cbranch_scc1 L_h_noq
    v_lshlrev_b32 v2, 4, v0
    ds_read_b128 v[32:35], v2 offset:4096
    ds_read_b128 v[36:39], v2 offset:5120
    ds_read_b128 v[40:43], v2 offset:6144
    ds_read_b128 v[44:47], v2 offset:7168
    s_waitcnt lgkmcnt(0)
    v_add_f32 v32, v32, v36
    v_add_f32 v40, v40, v44
    v_add_f32 v33, v33, v37
    v_add_f32 v41, v41, v45
    v_add_f32 v34, v34, v38
    v_add_f32 v42, v42, v46
    v_add_f32 v35, v35, v39
    v_add_f32 v43, v43, v47
    v_add_f32 v32, v32, v40
    v_add_f32 v33, v33, v41
    v_add_f32 v34, v34, v42
    v_add_f32 v35, v35, v43
    v_and_b32 v3, 31, v0
    v_lshlrev_b32 v3, 4, v3
    v_lshrrev_b32 v4, 5, v0
    v_lshl_add_u32 v3, v4, 14, v3
    s_and_b32 s7, s2, 7
    s_lshl_b32 s7, s7, 15
    s_lshr_b32 s8, s2, 3
    s_lshl_b32 s8, s8, 9
    s_add_u32 s7, s7, s8
    buffer_store_dwordx4 v[32:35], v3, s[92:95], s7 offen sc1
    v_mov_b32 v2, 0
L_bootq:
    buffer_load_dwordx4 v[36:39], v2, s[88:91], 0 offen sc1
    s_waitcnt vmcnt(0)
    v_and_b32 v36, v36, v37
    v_and_b32 v38, v38, v39
    v_and_b32 v36, v36, v38
    v_cmp_eq_u32 vcc, 0, v36
    s_cbranch_vccz L_bootdq
    s_sleep 8
    s_sub_u32 s14, s14, 1
    s_cmp_lg_u32 s14, 0
    s_cbranch_scc1 L_bootq
    s_mov_b32 s14, 1
L_bootdq:
    s_lshl_b32 s7, s2, 2
    s_add_u32 s7, s7, 1703936
    v_lshlrev_b32 v3, 10, v0
    s_mov_b32 exec_lo, 0xff
    s_mov_b32 exec_hi, 0x0
    v_mov_b32 v2, 0
    buffer_store_dword v2, v3, s[92:95], s7 offen sc1
    s_mov_b64 exec, -1
    s_branch L_h_q2
L_h_noq:
    s_waitcnt vmcnt(0)
L_h_q2:
    s_barrier
    s_cmp_lg_u32 s4, 1
    s_cbranch_scc1 L_h_nog
    v_lshlrev_b32 v2, 4, v0
    ds_read_b128 v[32:35], v2 offset:8192
    ds_read_b128 v[36:39], v2 offset:9216
    ds_read_b128 v[40:43], v2 offset:10240
    ds_read_b128 v[44:47], v2 offset:11264
    s_waitcnt lgkmcnt(0)
    v_add_f32 v32, v32, v36
    v_add_f32 v40, v40, v44
    v_add_f32 v33, v33, v37
    v_add_f32 v41, v41, v45
    v_add_f32 v34, v34, v38
    v_add_f32 v42, v42, v46
    v_add_f32 v35, v35, v39
    v_add_f32 v43, v43, v47
    v_add_f32 v32, v32, v40
    v_add_f32 v33, v33, v41
    v_add_f32 v34, v34, v42
    v_add_f32 v35, v35, v43
    v_and_b32 v3, 31, v0
    v_lshlrev_b32 v3, 4, v3
    v_lshrrev_b32 v4, 5, v0
    v_mul_u32_u24 v4, 14336, v4
    v_add_u32 v3, v4, v3
    s_lshr_b32 s8, s2, 2
    s_cmp_ge_u32 s8, 28
    s_cselect_b32 s7, 28, 0
    s_sub_u32 s8, s8, s7
    s_lshr_b32 s7, s2, 2
    s_cmp_ge_u32 s7, 28
    s_cselect_b32 s7, 4, 0
    s_and_b32 s15, s2, 3
    s_add_u32 s7, s7, s15
    s_mul_i32 s7, s7, 28672
    s_lshl_b32 s8, s8, 9
    s_add_u32 s7, s7, s8
    s_add_u32 s7, s7, 262144
    s_cmp_ge_u32 s2, 224
    s_cbranch_scc1 L_skipstg
    buffer_store_dwordx4 v[32:35], v3, s[92:95], s7 offen sc1
L_skipstg:
    v_mov_b32 v2, 0
L_bootg:
    buffer_load_dwordx4 v[36:39], v2, s[88:91], 0 offen sc1
    s_waitcnt vmcnt(0)
    v_and_b32 v36, v36, v37
    v_and_b32 v38, v38, v39
    v_and_b32 v36, v36, v38
    v_cmp_eq_u32 vcc, 0, v36
    s_cbranch_vccz L_bootdg
    s_sleep 8
    s_sub_u32 s14, s14, 1
    s_cmp_lg_u32 s14, 0
    s_cbranch_scc1 L_bootg
    s_mov_b32 s14, 1
L_bootdg:
    s_lshl_b32 s7, s2, 2
    s_add_u32 s7, s7, 1712128
    v_lshlrev_b32 v3, 10, v0
    s_mov_b32 exec_lo, 0xf
    s_mov_b32 exec_hi, 0x0
    v_mov_b32 v2, 0
    buffer_store_dword v2, v3, s[92:95], s7 offen sc1
    s_mov_b64 exec, -1
L_h_nog:
    s_cmp_lg_u32 s4, 0
    s_cbranch_scc1 L_qf_w
    s_lshr_b32 s8, s2, 5
    s_and_b32 s8, s8, 3
    s_lshl_b32 s8, s8, 8
    s_and_b32 s7, s2, 7
    s_lshl_b32 s7, s7, 10
    s_add_u32 s8, s8, s7
    s_add_u32 s8, s8, 1703936
    v_lshlrev_b32 v2, 2, v0
L_qpoll:
    buffer_load_dword v3, v2, s[92:95], s8 offen sc1
    s_waitcnt vmcnt(0)
    v_cmp_eq_u32 vcc, -1, v3
    s_cbranch_vccz L_qpoll_d
    s_sleep 4
    s_sub_u32 s14, s14, 1
    s_cmp_lg_u32 s14, 0
    s_cbranch_scc1 L_qpoll
    s_mov_b32 s14, 1
L_qpoll_d:
    v_mov_b32 v2, 0
    v_mov_b32 v3, 1
    ds_write_b32 v2, v3 offset:31296
    s_branch L_qf_d
L_qf_w:
    v_mov_b32 v2, 0
    ds_read_b32 v3, v2 offset:31296
    s_waitcnt lgkmcnt(0)
    v_readfirstlane_b32 s7, v3
    s_cmp_lg_u32 s7, 0
    s_cbranch_scc1 L_qf_d
    s_sleep 1
    s_sub_u32 s14, s14, 1
    s_cmp_lg_u32 s14, 0
    s_cbranch_scc1 L_qf_w
    s_mov_b32 s14, 1
    s_branch L_qf_d
L_qf_d:
    s_lshr_b32 s7, s2, 5
    s_lshl_b32 s7, s7, 12
    v_lshlrev_b32 v2, 4, v1
    s_add_u32 s8, s7, 0
    buffer_load_dwordx4 v[32:35], v2, s[92:95], s8 offen sc1
    s_add_u32 s8, s7, 32768
    buffer_load_dwordx4 v[36:39], v2, s[92:95], s8 offen sc1
    s_add_u32 s8, s7, 65536
    buffer_load_dwordx4 v[40:43], v2, s[92:95], s8 offen sc1
    s_add_u32 s8, s7, 98304
    buffer_load_dwordx4 v[44:47], v2, s[92:95], s8 offen sc1
    s_add_u32 s8, s7, 131072
    buffer_load_dwordx4 v[48:51], v2, s[92:95], s8 offen sc1
    s_add_u32 s8, s7, 163840
    buffer_load_dwordx4 v[52:55], v2, s[92:95], s8 offen sc1
    s_add_u32 s8, s7, 196608
    buffer_load_dwordx4 v[56:59], v2, s[92:95], s8 offen sc1
    s_add_u32 s8, s7, 229376
    buffer_load_dwordx4 v[60:63], v2, s[92:95], s8 offen sc1
    s_waitcnt vmcnt(0)
    v_add_f32 v32, v32, v36
    v_add_f32 v33, v33, v37
    v_add_f32 v34, v34, v38
    v_add_f32 v35, v35, v39
    v_add_f32 v32, v32, v40
    v_add_f32 v33, v33, v41
    v_add_f32 v34, v34, v42
    v_add_f32 v35, v35, v43
    v_add_f32 v32, v32, v44
    v_add_f32 v33, v33, v45
    v_add_f32 v34, v34, v46
    v_add_f32 v35, v35, v47
    v_add_f32 v32, v32, v48
    v_add_f32 v33, v33, v49
    v_add_f32 v34, v34, v50
    v_add_f32 v35, v35, v51
    v_add_f32 v32, v32, v52
    v_add_f32 v33, v33, v53
    v_add_f32 v34, v34, v54
    v_add_f32 v35, v35, v55
    v_add_f32 v32, v32, v56
    v_add_f32 v33, v33, v57
    v_add_f32 v34, v34, v58
    v_add_f32 v35, v35, v59
    v_add_f32 v32, v32, v60
    v_add_f32 v33, v33, v61
    v_add_f32 v34, v34, v62
    v_add_f32 v35, v35, v63
    v_cvt_pk_bf16_f32 v32, v32, v33
    v_cvt_pk_bf16_f32 v33, v34, v35
    v_lshlrev_b32 v2, 3, v1
    ds_write_b64 v2, v[32:33] offset:12288
    s_waitcnt lgkmcnt(0)
    s_barrier
    s_cmp_eq_u32 s4, 1
    s_cbranch_scc1 L_hf_w
    s_cmp_lg_u32 s4, 0
    s_cbranch_scc1 L_h_b5
    v_lshlrev_b32 v2, 4, v0
    s_and_b32 s7, s2, 3
    s_lshl_b32 s7, s7, 10
    s_add_u32 s7, s7, 1712128
L_hpoll:
    buffer_load_dwordx4 v[32:35], v2, s[92:95], s7 offen sc1
    s_waitcnt vmcnt(0)
    v_max3_u32 v3, v32, v33, v34
    v_max_u32 v3, v3, v35
    v_cmp_eq_u32 vcc, -1, v3
    s_cbranch_vccz L_hpoll_d
    s_sleep 16
    s_sub_u32 s14, s14, 1
    s_cmp_lg_u32 s14, 0
    s_cbranch_scc1 L_hpoll
    s_mov_b32 s14, 1
L_hpoll_d:
    v_mov_b32 v2, 0
    v_mov_b32 v3, 1
    ds_write_b32 v2, v3 offset:31300
    s_branch L_h_b5
L_hf_w:
    v_mov_b32 v2, 0
    ds_read_b32 v3, v2 offset:31300
    s_waitcnt lgkmcnt(0)
    v_readfirstlane_b32 s7, v3
    s_cmp_lg_u32 s7, 0
    s_cbranch_scc1 L_hf_d
    s_sleep 1
    s_sub_u32 s14, s14, 1
    s_cmp_lg_u32 s14, 0
    s_cbranch_scc1 L_hf_w
    s_mov_b32 s14, 1
    s_branch L_hf_d
L_hf_d:
    s_max_u32 s7, s2, 32
    s_sub_u32 s7, s7, 32
    s_lshr_b32 s7, s7, 1
    s_lshl_b32 s7, s7, 7
    v_and_b32 v2, 31, v0
    v_lshlrev_b32 v2, 2, v2
    v_lshrrev_b32 v3, 5, v0
    v_mul_u32_u24 v3, 14336, v3
    v_add_u32 v2, v2, v3
    s_add_u32 s8, s7, 262144
    buffer_load_dword v32, v2, s[92:95], s8 offen sc1
    s_add_u32 s8, s7, 290816
    buffer_load_dword v33, v2, s[92:95], s8 offen sc1
    s_add_u32 s8, s7, 319488
    buffer_load_dword v34, v2, s[92:95], s8 offen sc1
    s_add_u32 s8, s7, 348160
    buffer_load_dword v35, v2, s[92:95], s8 offen sc1
    s_add_u32 s8, s7, 376832
    buffer_load_dword v36, v2, s[92:95], s8 offen sc1
    s_add_u32 s8, s7, 405504
    buffer_load_dword v37, v2, s[92:95], s8 offen sc1
    s_add_u32 s8, s7, 434176
    buffer_load_dword v38, v2, s[92:95], s8 offen sc1
    s_add_u32 s8, s7, 462848
    buffer_load_dword v39, v2, s[92:95], s8 offen sc1
    s_waitcnt vmcnt(0)
    v_add_f32 v32, v32, v33
    v_add_f32 v34, v34, v35
    v_add_f32 v32, v32, v34
    v_cvt_pk_bf16_f32 v3, v32, v32
    v_lshlrev_b32 v32, 16, v3
    v_add_f32 v36, v36, v37
    v_add_f32 v38, v38, v39
    v_add_f32 v36, v36, v38
    v_cvt_pk_bf16_f32 v3, v36, v36
    v_lshlrev_b32 v36, 16, v3
    v_mul_f32 v3, 0xbfb8aa3b, v32
    v_exp_f32 v3, v3
    s_nop 0
    v_add_f32 v3, 1.0, v3
    v_rcp_f32 v3, v3
    s_nop 0
    v_mul_f32 v32, v32, v3
    v_cvt_pk_bf16_f32 v3, v32, v32
    v_lshlrev_b32 v32, 16, v3
    v_mul_f32 v32, v32, v36
    v_cvt_pk_bf16_f32 v32, v32, v32
    v_lshlrev_b32 v2, 1, v0
    ds_write_b16 v2, v32 offset:30976
    s_waitcnt lgkmcnt(0)
L_h_b5:
    s_waitcnt lgkmcnt(0)
    s_barrier
    v_lshrrev_b32 v2, 5, v1
    v_lshlrev_b32 v3, 5, v2
    ds_read_b128 v[16:19], v3 offset:30720
    ds_read_b128 v[20:23], v3 offset:30736
    v_lshlrev_b32 v4, 4, v1
    ds_read_b128 v[32:35], v4 offset:14336
    ds_read_b128 v[36:39], v4 offset:18432
    ds_read_b128 v[40:43], v4 offset:22528
    ds_read_b128 v[44:47], v4 offset:26624
    s_mov_b32 s8, 0x3fb8aa3b
    s_waitcnt lgkmcnt(4)
    v_max3_f32 v5, v16, v18, v20
    v_max_f32 v5, v5, v22
    v_sub_f32 v16, v16, v5
    v_mul_f32 v16, s8, v16
    v_exp_f32 v16, v16
    v_sub_f32 v18, v18, v5
    v_mul_f32 v18, s8, v18
    v_exp_f32 v18, v18
    v_sub_f32 v20, v20, v5
    v_mul_f32 v20, s8, v20
    v_exp_f32 v20, v20
    v_sub_f32 v22, v22, v5
    v_mul_f32 v22, s8, v22
    v_exp_f32 v22, v22
    s_nop 0
    v_mul_f32 v6, v16, v17
    v_fmac_f32 v6, v18, v19
    v_fmac_f32 v6, v20, v21
    v_fmac_f32 v6, v22, v23
    s_waitcnt lgkmcnt(0)
    v_mul_f32 v32, v16, v32
    v_mul_f32 v33, v16, v33
    v_mul_f32 v34, v16, v34
    v_mul_f32 v35, v16, v35
    v_fmac_f32 v32, v18, v36
    v_fmac_f32 v33, v18, v37
    v_fmac_f32 v34, v18, v38
    v_fmac_f32 v35, v18, v39
    v_fmac_f32 v32, v20, v40
    v_fmac_f32 v33, v20, v41
    v_fmac_f32 v34, v20, v42
    v_fmac_f32 v35, v20, v43
    v_fmac_f32 v32, v22, v44
    v_fmac_f32 v33, v22, v45
    v_fmac_f32 v34, v22, v46
    v_fmac_f32 v35, v22, v47
    v_min_u32 v32, 0xfffffffe, v32
    v_min_u32 v33, 0xfffffffe, v33
    v_min_u32 v34, 0xfffffffe, v34
    v_min_u32 v35, 0xfffffffe, v35
    v_min_u32 v5, 0xfffffffe, v5
    v_min_u32 v6, 0xfffffffe, v6
    s_lshl_b32 s7, s2, 12
    s_add_u32 s7, s7, 524288
    buffer_store_dwordx4 v[32:35], v4, s[92:95], s7 offen sc1
    s_lshr_b32 s7, s2, 5
    s_lshl_b32 s7, s7, 11
    s_and_b32 s8, s2, 31
    s_lshl_b32 s8, s8, 3
    s_add_u32 s7, s7, s8
    s_add_u32 s7, s7, 1572864
    v_lshlrev_b32 v3, 8, v2
    v_mov_b32 v24, v5
    v_mov_b32 v25, v6
    s_mov_b32 exec_lo, 0x1
    s_mov_b32 exec_hi, 0x1
    buffer_store_dwordx2 v[24:25], v3, s[92:95], s7 offen sc1
    s_mov_b64 exec, -1
    s_lshr_b32 s5, s4, 1
    s_lshl_b32 s5, s5, 2
    s_lshr_b32 s6, s2, 6
    s_add_u32 s5, s5, s6
    s_lshr_b32 s6, s2, 3
    s_and_b32 s6, s6, 7
    s_lshl_b32 s7, s5, 17
    s_lshl_b32 s8, s6, 9
    s_add_u32 s7, s7, s8
    s_lshr_b32 s8, s2, 1
    s_and_b32 s8, s8, 3
    s_lshl_b32 s8, s8, 7
    s_add_u32 s7, s7, s8
    s_and_b32 s8, s4, 1
    s_lshl_b32 s8, s8, 6
    s_add_u32 s7, s7, s8
    s_add_u32 s7, s7, 524288
    s_lshl_b32 s8, s5, 11
    s_lshl_b32 s6, s6, 8
    s_add_u32 s8, s8, s6
    s_add_u32 s8, s8, 1572864
    v_and_b32 v2, 31, v0
    v_lshrrev_b32 v3, 5, v0
    v_lshlrev_b32 v4, 3, v2
    v_lshlrev_b32 v3, 5, v3
    v_lshl_add_u32 v3, v2, 12, v3
L_l1f:
    buffer_load_dwordx2 v[40:41], v4, s[92:95], s8 offen sc1
    s_waitcnt vmcnt(0)
    v_max_u32 v5, v40, v41
    v_cmp_eq_u32 vcc, -1, v5
    s_bcnt1_i32_b64 s6, vcc
    s_cmp_le_u32 s6, 8
    s_cbranch_scc1 L_l1poll
    s_sleep 16
    s_sub_u32 s14, s14, 1
    s_cmp_lg_u32 s14, 0
    s_cbranch_scc1 L_l1f
    s_mov_b32 s14, 1
L_l1poll:
    buffer_load_dwordx4 v[32:35], v3, s[92:95], s7 offen sc1
    buffer_load_dwordx4 v[36:39], v3, s[92:95], s7 offen offset:16 sc1
    buffer_load_dwordx2 v[40:41], v4, s[92:95], s8 offen sc1
    s_waitcnt vmcnt(0)
    v_max3_u32 v5, v32, v33, v34
    v_max3_u32 v6, v35, v36, v37
    v_max3_u32 v5, v5, v38, v39
    v_max3_u32 v6, v6, v40, v41
    v_max_u32 v5, v5, v6
    v_cmp_eq_u32 vcc, -1, v5
    s_cbranch_vccz L_l1poll_d
    s_sleep 8
    s_sub_u32 s14, s14, 1
    s_cmp_lg_u32 s14, 0
    s_cbranch_scc1 L_l1poll
    s_mov_b32 s14, 1
L_l1poll_d:
    v_mov_b32 v5, v40
    s_nop 1
    v_max_f32_dpp v5, v5, v5 quad_perm:[1,0,3,2] row_mask:0xf bank_mask:0xf
    s_nop 1
    v_max_f32_dpp v5, v5, v5 quad_perm:[2,3,0,1] row_mask:0xf bank_mask:0xf
    s_nop 1
    v_max_f32_dpp v5, v5, v5 row_half_mirror row_mask:0xf bank_mask:0xf
    s_nop 1
    v_max_f32_dpp v5, v5, v5 row_mirror row_mask:0xf bank_mask:0xf
    v_mov_b32 v16, v5
    s_nop 1
    v_permlane16_swap_b32 v5, v16
    v_max_f32 v5, v5, v16
    s_mov_b32 s6, 0x3fb8aa3b
    v_sub_f32 v5, v40, v5
    v_mul_f32 v5, s6, v5
    v_exp_f32 v5, v5
    s_nop 0
    v_mul_f32 v32, v5, v32
    v_mul_f32 v33, v5, v33
    v_mul_f32 v34, v5, v34
    v_mul_f32 v35, v5, v35
    v_mul_f32 v36, v5, v36
    v_mul_f32 v37, v5, v37
    v_mul_f32 v38, v5, v38
    v_mul_f32 v39, v5, v39
    v_mul_f32 v40, v5, v41
    v_add_f32_dpp v32, v32, v32 quad_perm:[1,0,3,2] row_mask:0xf bank_mask:0xf
    v_add_f32_dpp v33, v33, v33 quad_perm:[1,0,3,2] row_mask:0xf bank_mask:0xf
    v_add_f32_dpp v34, v34, v34 quad_perm:[1,0,3,2] row_mask:0xf bank_mask:0xf
    v_add_f32_dpp v35, v35, v35 quad_perm:[1,0,3,2] row_mask:0xf bank_mask:0xf
    v_add_f32_dpp v36, v36, v36 quad_perm:[1,0,3,2] row_mask:0xf bank_mask:0xf
    v_add_f32_dpp v37, v37, v37 quad_perm:[1,0,3,2] row_mask:0xf bank_mask:0xf
    v_add_f32_dpp v38, v38, v38 quad_perm:[1,0,3,2] row_mask:0xf bank_mask:0xf
    v_add_f32_dpp v39, v39, v39 quad_perm:[1,0,3,2] row_mask:0xf bank_mask:0xf
    v_add_f32_dpp v40, v40, v40 quad_perm:[1,0,3,2] row_mask:0xf bank_mask:0xf
    v_add_f32_dpp v32, v32, v32 quad_perm:[2,3,0,1] row_mask:0xf bank_mask:0xf
    v_add_f32_dpp v33, v33, v33 quad_perm:[2,3,0,1] row_mask:0xf bank_mask:0xf
    v_add_f32_dpp v34, v34, v34 quad_perm:[2,3,0,1] row_mask:0xf bank_mask:0xf
    v_add_f32_dpp v35, v35, v35 quad_perm:[2,3,0,1] row_mask:0xf bank_mask:0xf
    v_add_f32_dpp v36, v36, v36 quad_perm:[2,3,0,1] row_mask:0xf bank_mask:0xf
    v_add_f32_dpp v37, v37, v37 quad_perm:[2,3,0,1] row_mask:0xf bank_mask:0xf
    v_add_f32_dpp v38, v38, v38 quad_perm:[2,3,0,1] row_mask:0xf bank_mask:0xf
    v_add_f32_dpp v39, v39, v39 quad_perm:[2,3,0,1] row_mask:0xf bank_mask:0xf
    v_add_f32_dpp v40, v40, v40 quad_perm:[2,3,0,1] row_mask:0xf bank_mask:0xf
    v_add_f32_dpp v32, v32, v32 row_half_mirror row_mask:0xf bank_mask:0xf
    v_add_f32_dpp v33, v33, v33 row_half_mirror row_mask:0xf bank_mask:0xf
    v_add_f32_dpp v34, v34, v34 row_half_mirror row_mask:0xf bank_mask:0xf
    v_add_f32_dpp v35, v35, v35 row_half_mirror row_mask:0xf bank_mask:0xf
    v_add_f32_dpp v36, v36, v36 row_half_mirror row_mask:0xf bank_mask:0xf
    v_add_f32_dpp v37, v37, v37 row_half_mirror row_mask:0xf bank_mask:0xf
    v_add_f32_dpp v38, v38, v38 row_half_mirror row_mask:0xf bank_mask:0xf
    v_add_f32_dpp v39, v39, v39 row_half_mirror row_mask:0xf bank_mask:0xf
    v_add_f32_dpp v40, v40, v40 row_half_mirror row_mask:0xf bank_mask:0xf
    v_add_f32_dpp v32, v32, v32 row_mirror row_mask:0xf bank_mask:0xf
    v_add_f32_dpp v33, v33, v33 row_mirror row_mask:0xf bank_mask:0xf
    v_add_f32_dpp v34, v34, v34 row_mirror row_mask:0xf bank_mask:0xf
    v_add_f32_dpp v35, v35, v35 row_mirror row_mask:0xf bank_mask:0xf
    v_add_f32_dpp v36, v36, v36 row_mirror row_mask:0xf bank_mask:0xf
    v_add_f32_dpp v37, v37, v37 row_mirror row_mask:0xf bank_mask:0xf
    v_add_f32_dpp v38, v38, v38 row_mirror row_mask:0xf bank_mask:0xf
    v_add_f32_dpp v39, v39, v39 row_mirror row_mask:0xf bank_mask:0xf
    v_add_f32_dpp v40, v40, v40 row_mirror row_mask:0xf bank_mask:0xf
    v_mov_b32 v16, v32
    v_mov_b32 v17, v33
    v_mov_b32 v18, v34
    v_mov_b32 v19, v35
    v_mov_b32 v20, v36
    v_mov_b32 v21, v37
    v_mov_b32 v22, v38
    v_mov_b32 v23, v39
    v_mov_b32 v24, v40
    s_nop 1
    v_permlane16_swap_b32 v32, v16
    v_permlane16_swap_b32 v33, v17
    v_permlane16_swap_b32 v34, v18
    v_permlane16_swap_b32 v35, v19
    v_permlane16_swap_b32 v36, v20
    v_permlane16_swap_b32 v37, v21
    v_permlane16_swap_b32 v38, v22
    v_permlane16_swap_b32 v39, v23
    v_permlane16_swap_b32 v40, v24
    v_add_f32 v32, v32, v16
    v_add_f32 v33, v33, v17
    v_add_f32 v34, v34, v18
    v_add_f32 v35, v35, v19
    v_add_f32 v36, v36, v20
    v_add_f32 v37, v37, v21
    v_add_f32 v38, v38, v22
    v_add_f32 v39, v39, v23
    v_add_f32 v40, v40, v24
    v_rcp_f32 v5, v40
    s_nop 0
    v_mul_f32 v32, v5, v32
    v_mul_f32 v33, v5, v33
    v_mul_f32 v34, v5, v34
    v_mul_f32 v35, v5, v35
    v_mul_f32 v36, v5, v36
    v_mul_f32 v37, v5, v37
    v_mul_f32 v38, v5, v38
    v_mul_f32 v39, v5, v39
    v_cvt_pk_bf16_f32 v32, v32, v33
    v_cvt_pk_bf16_f32 v33, v34, v35
    v_cvt_pk_bf16_f32 v34, v36, v37
    v_cvt_pk_bf16_f32 v35, v38, v39
    s_lshl_b32 s6, s4, 5
    v_lshrrev_b32 v2, 5, v0
    v_lshlrev_b32 v2, 4, v2
    v_add_u32 v2, s6, v2
    s_mov_b32 exec_lo, 0x1
    s_mov_b32 exec_hi, 0x1
    ds_write_b128 v2, v[32:35] offset:31104
    s_mov_b64 exec, -1
    s_waitcnt lgkmcnt(0)
    s_barrier
    s_cmp_lg_u32 s4, 2
    s_cbranch_scc1 L_h_nof
    s_sleep 24
    s_lshl_b32 s7, s2, 12
    s_add_u32 s7, s7, 3145728
    v_lshlrev_b32 v2, 4, v0
L_fmb:
    buffer_load_dwordx4 v[32:35], v2, s[92:95], s7 offen offset:0 sc1
    buffer_load_dwordx4 v[36:39], v2, s[92:95], s7 offen offset:1024 sc1
    buffer_load_dwordx4 v[40:43], v2, s[92:95], s7 offen offset:2048 sc1
    buffer_load_dwordx4 v[44:47], v2, s[92:95], s7 offen offset:3072 sc1
    s_waitcnt vmcnt(0)
    v_max3_u32 v5, v32, v33, v34
    v_max3_u32 v6, v35, v36, v37
    v_max3_u32 v5, v5, v38, v39
    v_max3_u32 v6, v6, v40, v41
    v_max3_u32 v5, v5, v42, v43
    v_max3_u32 v6, v6, v44, v45
    v_max3_u32 v5, v5, v46, v47
    v_max_u32 v5, v5, v6
    v_cmp_eq_u32 vcc, -1, v5
    s_cbranch_vccz L_fmb_d
    s_sleep 8
    s_sub_u32 s14, s14, 1
    s_cmp_lg_u32 s14, 0
    s_cbranch_scc1 L_fmb
    s_mov_b32 s14, 1
L_fmb_d:
    v_add_f32 v32, v32, v36
    v_add_f32 v40, v40, v44
    v_add_f32 v33, v33, v37
    v_add_f32 v41, v41, v45
    v_add_f32 v34, v34, v38
    v_add_f32 v42, v42, v46
    v_add_f32 v35, v35, v39
    v_add_f32 v43, v43, v47
    v_add_f32 v32, v32, v40
    v_add_f32 v33, v33, v41
    v_add_f32 v34, v34, v42
    v_add_f32 v35, v35, v43
    v_add_f32_dpp v32, v32, v32 quad_perm:[2,3,0,1] row_mask:0xf bank_mask:0xf
    v_add_f32_dpp v33, v33, v33 quad_perm:[2,3,0,1] row_mask:0xf bank_mask:0xf
    v_add_f32_dpp v34, v34, v34 quad_perm:[2,3,0,1] row_mask:0xf bank_mask:0xf
    v_add_f32_dpp v35, v35, v35 quad_perm:[2,3,0,1] row_mask:0xf bank_mask:0xf
    v_add_f32_dpp v32, v32, v32 row_ror:4 row_mask:0xf bank_mask:0xf
    v_add_f32_dpp v33, v33, v33 row_ror:4 row_mask:0xf bank_mask:0xf
    v_add_f32_dpp v34, v34, v34 row_ror:4 row_mask:0xf bank_mask:0xf
    v_add_f32_dpp v35, v35, v35 row_ror:4 row_mask:0xf bank_mask:0xf
    v_add_f32_dpp v32, v32, v32 row_ror:8 row_mask:0xf bank_mask:0xf
    v_add_f32_dpp v33, v33, v33 row_ror:8 row_mask:0xf bank_mask:0xf
    v_add_f32_dpp v34, v34, v34 row_ror:8 row_mask:0xf bank_mask:0xf
    v_add_f32_dpp v35, v35, v35 row_ror:8 row_mask:0xf bank_mask:0xf
    v_mov_b32 v16, v32
    v_mov_b32 v17, v33
    v_mov_b32 v18, v34
    v_mov_b32 v19, v35
    s_nop 1
    v_permlane16_swap_b32 v32, v16
    v_permlane16_swap_b32 v33, v17
    v_permlane16_swap_b32 v34, v18
    v_permlane16_swap_b32 v35, v19
    v_add_f32 v32, v32, v16
    v_add_f32 v33, v33, v17
    v_add_f32 v34, v34, v18
    v_add_f32 v35, v35, v19
    v_mov_b32 v16, v32
    v_mov_b32 v17, v33
    v_mov_b32 v18, v34
    v_mov_b32 v19, v35
    s_nop 1
    v_permlane32_swap_b32 v32, v16
    v_permlane32_swap_b32 v33, v17
    v_permlane32_swap_b32 v34, v18
    v_permlane32_swap_b32 v35, v19
    v_add_f32 v32, v32, v16
    v_add_f32 v33, v33, v17
    v_add_f32 v34, v34, v18
    v_add_f32 v35, v35, v19
    v_cvt_pk_bf16_f32 v3, v32, v32
    v_lshlrev_b32 v32, 16, v3
    v_mul_f32 v3, 0xbfb8aa3b, v32
    v_exp_f32 v3, v3
    s_nop 0
    v_add_f32 v3, 1.0, v3
    v_rcp_f32 v3, v3
    s_nop 0
    v_mul_f32 v32, v32, v3
    v_cvt_pk_bf16_f32 v3, v32, v32
    v_lshlrev_b32 v32, 16, v3
    v_cvt_pk_bf16_f32 v3, v33, v33
    v_lshlrev_b32 v33, 16, v3
    v_mul_f32 v3, 0xbfb8aa3b, v33
    v_exp_f32 v3, v3
    s_nop 0
    v_add_f32 v3, 1.0, v3
    v_rcp_f32 v3, v3
    s_nop 0
    v_mul_f32 v33, v33, v3
    v_cvt_pk_bf16_f32 v3, v33, v33
    v_lshlrev_b32 v33, 16, v3
    v_cvt_pk_bf16_f32 v3, v34, v34
    v_lshlrev_b32 v34, 16, v3
    v_mul_f32 v3, 0xbfb8aa3b, v34
    v_exp_f32 v3, v3
    s_nop 0
    v_add_f32 v3, 1.0, v3
    v_rcp_f32 v3, v3
    s_nop 0
    v_mul_f32 v34, v34, v3
    v_cvt_pk_bf16_f32 v3, v34, v34
    v_lshlrev_b32 v34, 16, v3
    v_cvt_pk_bf16_f32 v3, v35, v35
    v_lshlrev_b32 v35, 16, v3
    v_mul_f32 v3, 0xbfb8aa3b, v35
    v_exp_f32 v3, v3
    s_nop 0
    v_add_f32 v3, 1.0, v3
    v_rcp_f32 v3, v3
    s_nop 0
    v_mul_f32 v35, v35, v3
    v_cvt_pk_bf16_f32 v3, v35, v35
    v_lshlrev_b32 v35, 16, v3
    s_mov_b32 exec_lo, 0x3
    s_mov_b32 exec_hi, 0x0
    ds_write_b128 v2, v[32:35] offset:31232
    s_mov_b64 exec, -1
    s_waitcnt lgkmcnt(0)
    v_mov_b32 v2, 0
    v_mov_b32 v3, 1
    ds_write_b32 v2, v3 offset:31304
    s_branch L_h_end
L_h_nof:
    s_cmp_lg_u32 s4, 0
    s_cbranch_scc1 L_h_end
    v_and_b32 v4, 1, v0
    s_sleep 40
    s_lshl_b32 s7, s2, 12
    s_add_u32 s7, s7, 2097152
    v_lshlrev_b32 v2, 4, v0
L_smb:
    buffer_load_dwordx4 v[32:35], v2, s[92:95], s7 offen offset:0 sc1
    buffer_load_dwordx4 v[36:39], v2, s[92:95], s7 offen offset:1024 sc1
    buffer_load_dwordx4 v[40:43], v2, s[92:95], s7 offen offset:2048 sc1
    buffer_load_dwordx4 v[44:47], v2, s[92:95], s7 offen offset:3072 sc1
    s_waitcnt vmcnt(0)
    v_max3_u32 v5, v32, v33, v34
    v_max3_u32 v6, v35, v36, v37
    v_max3_u32 v5, v5, v38, v39
    v_max3_u32 v6, v6, v40, v41
    v_max3_u32 v5, v5, v42, v43
    v_max3_u32 v6, v6, v44, v45
    v_max3_u32 v5, v5, v46, v47
    v_max_u32 v5, v5, v6
    v_cmp_eq_u32 vcc, -1, v5
    s_cbranch_vccz L_smb_d
    s_sleep 8
    s_sub_u32 s14, s14, 1
    s_cmp_lg_u32 s14, 0
    s_cbranch_scc1 L_smb
    s_mov_b32 s14, 1
L_smb_d:
    v_add_f32 v32, v32, v36
    v_add_f32 v40, v40, v44
    v_add_f32 v33, v33, v37
    v_add_f32 v41, v41, v45
    v_add_f32 v34, v34, v38
    v_add_f32 v42, v42, v46
    v_add_f32 v35, v35, v39
    v_add_f32 v43, v43, v47
    v_add_f32 v32, v32, v40
    v_add_f32 v33, v33, v41
    v_add_f32 v34, v34, v42
    v_add_f32 v35, v35, v43
    v_add_f32_dpp v32, v32, v32 quad_perm:[2,3,0,1] row_mask:0xf bank_mask:0xf
    v_add_f32_dpp v33, v33, v33 quad_perm:[2,3,0,1] row_mask:0xf bank_mask:0xf
    v_add_f32_dpp v34, v34, v34 quad_perm:[2,3,0,1] row_mask:0xf bank_mask:0xf
    v_add_f32_dpp v35, v35, v35 quad_perm:[2,3,0,1] row_mask:0xf bank_mask:0xf
    v_add_f32_dpp v32, v32, v32 row_ror:4 row_mask:0xf bank_mask:0xf
    v_add_f32_dpp v33, v33, v33 row_ror:4 row_mask:0xf bank_mask:0xf
    v_add_f32_dpp v34, v34, v34 row_ror:4 row_mask:0xf bank_mask:0xf
    v_add_f32_dpp v35, v35, v35 row_ror:4 row_mask:0xf bank_mask:0xf
    v_add_f32_dpp v32, v32, v32 row_ror:8 row_mask:0xf bank_mask:0xf
    v_add_f32_dpp v33, v33, v33 row_ror:8 row_mask:0xf bank_mask:0xf
    v_add_f32_dpp v34, v34, v34 row_ror:8 row_mask:0xf bank_mask:0xf
    v_add_f32_dpp v35, v35, v35 row_ror:8 row_mask:0xf bank_mask:0xf
    v_mov_b32 v16, v32
    v_mov_b32 v17, v33
    v_mov_b32 v18, v34
    v_mov_b32 v19, v35
    s_nop 1
    v_permlane16_swap_b32 v32, v16
    v_permlane16_swap_b32 v33, v17
    v_permlane16_swap_b32 v34, v18
    v_permlane16_swap_b32 v35, v19
    v_add_f32 v32, v32, v16
    v_add_f32 v33, v33, v17
    v_add_f32 v34, v34, v18
    v_add_f32 v35, v35, v19
    v_mov_b32 v16, v32
    v_mov_b32 v17, v33
    v_mov_b32 v18, v34
    v_mov_b32 v19, v35
    s_nop 1
    v_permlane32_swap_b32 v32, v16
    v_permlane32_swap_b32 v33, v17
    v_permlane32_swap_b32 v34, v18
    v_permlane32_swap_b32 v35, v19
    v_add_f32 v32, v32, v16
    v_add_f32 v33, v33, v17
    v_add_f32 v34, v34, v18
    v_add_f32 v35, v35, v19
L_g2f_w:
    v_mov_b32 v2, 0
    ds_read_b32 v3, v2 offset:31304
    s_waitcnt lgkmcnt(0)
    v_readfirstlane_b32 s7, v3
    s_cmp_lg_u32 s7, 0
    s_cbranch_scc1 L_g2f_d
    s_sleep 1
    s_sub_u32 s14, s14, 1
    s_cmp_lg_u32 s14, 0
    s_cbranch_scc1 L_g2f_w
    s_mov_b32 s14, 1
    s_branch L_g2f_d
L_g2f_d:
    v_lshlrev_b32 v3, 4, v4
    ds_read_b128 v[24:27], v3 offset:31232
    s_mov_b32 s7, 0xffff0000
    v_lshlrev_b32 v16, 16, v8
    v_and_b32 v17, s7, v8
    v_lshlrev_b32 v18, 16, v9
    v_and_b32 v19, s7, v9
    s_waitcnt lgkmcnt(0)
    v_cvt_pk_bf16_f32 v3, v32, v32
    v_lshlrev_b32 v32, 16, v3
    v_mul_f32 v32, v32, v24
    v_cvt_pk_bf16_f32 v3, v32, v32
    v_lshlrev_b32 v32, 16, v3
    v_add_f32 v32, v16, v32
    v_cvt_pk_bf16_f32 v3, v33, v33
    v_lshlrev_b32 v33, 16, v3
    v_mul_f32 v33, v33, v25
    v_cvt_pk_bf16_f32 v3, v33, v33
    v_lshlrev_b32 v33, 16, v3
    v_add_f32 v33, v17, v33
    v_cvt_pk_bf16_f32 v3, v34, v34
    v_lshlrev_b32 v34, 16, v3
    v_mul_f32 v34, v34, v26
    v_cvt_pk_bf16_f32 v3, v34, v34
    v_lshlrev_b32 v34, 16, v3
    v_add_f32 v34, v18, v34
    v_cvt_pk_bf16_f32 v3, v35, v35
    v_lshlrev_b32 v35, 16, v3
    v_mul_f32 v35, v35, v27
    v_cvt_pk_bf16_f32 v3, v35, v35
    v_lshlrev_b32 v35, 16, v3
    v_add_f32 v35, v19, v35
    v_cvt_pk_bf16_f32 v32, v32, v33
    v_cvt_pk_bf16_f32 v33, v34, v35
    s_lshl_b32 s5, s2, 3
    v_lshlrev_b32 v2, 11, v4
    s_mov_b32 exec_lo, 0x3
    s_mov_b32 exec_hi, 0x0
    buffer_store_dwordx2 v[32:33], v2, s[84:87], s5 offen
    s_mov_b64 exec, -1
L_h_end:
L_end:
    s_endpgm
.section .rodata,"a"
.p2align 6
.amdhsa_kernel recurrent_scan__gqa_block_cached__swiglu_ffn__decode_kernel
  .amdhsa_next_free_vgpr 248
  .amdhsa_next_free_sgpr 102
  .amdhsa_accum_offset 248
  .amdhsa_group_segment_fixed_size 0
  .amdhsa_kernarg_size 96
  .amdhsa_user_sgpr_count 2
  .amdhsa_user_sgpr_kernarg_segment_ptr 1
  .amdhsa_system_sgpr_workgroup_id_x 1
.end_amdhsa_kernel
```
